```python
import torch

def _softmax(x, axis=-1):
    return torch.softmax(x, dim=axis)
def _gelu(x):
    return torch.nn.functional.gelu(x, approximate="tanh")
def _silu(x):
    return torch.nn.functional.silu(x)
def _sigmoid(x):
    return torch.sigmoid(x)
def _layernorm(x, axis=-1, eps=1e-5):
    m = x.mean(dim=axis, keepdim=True)
    v = x.var(dim=axis, keepdim=True, unbiased=False)
    return (x - m) / torch.sqrt(v + eps)
def _scatter_add(tgt, idx, src, axis=0):
    return tgt.clone().index_add_(axis, idx, src)
def _segment_sum(src, seg, n):
    out = torch.zeros((n,) + src.shape[1:], dtype=src.dtype)
    return out.index_add_(0, seg, src)
def _pad(x, pw):
    flat = tuple(v for pair in reversed(pw) for v in pair)
    return torch.nn.functional.pad(x, flat)

kernel_name = 'sequential_preLN__sliding_block_cached__swiglu_ffn__decode'

def setup_inputs():

    _w = (lambda a: (lambda t: t.to(torch.bfloat16) if t.is_floating_point() else t)(torch.as_tensor(a)))
    def _A_setup():
        B, Sq, D = 4, 1, 512
        Hq, Hkv, Sk, Dh = 32, 8, 16384, 128
        assert Hq % Hkv == 0, (Hq, Hkv)
        return {
            "x": _w((lambda *s: torch.randn(*s, dtype=torch.bfloat16) * 0.05)(B, Sq, D)),
            "k_cache": _w((lambda *s: torch.randn(*s, dtype=torch.bfloat16) * 3.2)(B, Hkv, Sk, Dh)),
            "v_cache": _w((lambda *s: torch.randn(*s, dtype=torch.bfloat16) * 0.4)(B, Hkv, Sk, Dh)),
            "wq": _w((lambda *s: torch.randn(*s, dtype=torch.bfloat16) * 3.2)(D, Hq * Dh) * (D ** -0.5)),
            "wo": _w((lambda *s: torch.randn(*s, dtype=torch.bfloat16) * 0.4)(Hq * Dh, D) * ((Hq * Dh) ** -0.5)),
        }
    _A_in = _A_setup()

    def _B_setup():
        B, S, D, F = 4, 1, 512, 1792
        return {
            "x": _w((lambda *s: torch.randn(*s, dtype=torch.bfloat16) * 0.05)(B, S, D)),
            "w_gate": _w((lambda *s: torch.randn(*s, dtype=torch.bfloat16) * 0.05)(D, F)),
            "w_up": _w((lambda *s: torch.randn(*s, dtype=torch.bfloat16) * 0.05)(D, F)),
            "w_down": _w((lambda *s: torch.randn(*s, dtype=torch.bfloat16) * 0.05)(F, D)),
        }
    _B_in = _B_setup()

    return {
        "A_x": _A_in["x"],
        "A_k_cache": _A_in["k_cache"],
        "A_v_cache": _A_in["v_cache"],
        "A_wq": _A_in["wq"],
        "A_wo": _A_in["wo"],
        "B_x": _B_in["x"],
        "B_w_gate": _B_in["w_gate"],
        "B_w_up": _B_in["w_up"],
        "B_w_down": _B_in["w_down"],
    }

def reference(A_x, A_k_cache, A_v_cache, A_wq, A_wo, B_x, B_w_gate, B_w_up, B_w_down):
    def _A_ref(x, k_cache, v_cache, wq, wo):
        B, Sq, D = x.shape
        Hq, Dh = 32, 128
        Hkv, Sk = k_cache.shape[1], k_cache.shape[2]
        W = min(4096, max(256, Sk // 4))
        rep = Hq // Hkv
        q = (lambda x, *d: x.permute(*d))((x @ wq).reshape(B, Sq, Hq, Dh), 0, 2, 1, 3)
        k = (lambda x, n, axis: torch.repeat_interleave(x, n, dim=axis))(k_cache[:, :, Sk - W:, :], rep, axis=1)
        v = (lambda x, n, axis: torch.repeat_interleave(x, n, dim=axis))(v_cache[:, :, Sk - W:, :], rep, axis=1)
        scores = torch.einsum("bhqd,bhkd->bhqk", q, k) * (Dh ** -0.5)
        p = _softmax(scores, axis=-1)
        o = torch.einsum("bhqk,bhkd->bhqd", p, v)
        return (lambda x, *d: x.permute(*d))(o, 0, 2, 1, 3).reshape(B, Sq, Hq * Dh) @ wo

    def _B_ref(x, w_gate, w_up, w_down):
        g = _silu(x @ w_gate)
        u = x @ w_up
        return (g * u) @ w_down

    x = A_x
    h = x + _A_ref(_layernorm(x, axis=-1), A_k_cache, A_v_cache, A_wq, A_wo)
    h2 = h + _B_ref(_layernorm(h, axis=-1), B_w_gate, B_w_up, B_w_down)
    return h2
```

```asm
; @launch grid=(256,1,1) block=(512,1,1) lds=163840
.amdgcn_target "amdgcn-amd-amdhsa--gfx950"
.text
.globl sequential_preLN__sliding_block_cached__swiglu_ffn__decode_kernel
.p2align 12
.p2align 8
.type sequential_preLN__sliding_block_cached__swiglu_ffn__decode_kernel,@function
sequential_preLN__sliding_block_cached__swiglu_ffn__decode_kernel:
    s_load_dwordx16 s[4:19], s[0:1], 0
    s_load_dwordx8 s[20:27], s[0:1], 64
    v_lshrrev_b32 v4, 6, v0
    v_and_b32 v1, 63, v0
    v_readfirstlane_b32 s68, v4
    s_lshr_b32 s70, s2, 3
    s_cmp_ge_u32 s70, 32
    s_cbranch_scc1 L_end
    v_lshrrev_b32 v3, 4, v1
    s_and_b32 s69, s2, 7
    s_cbranch_scc0 L_tail
    s_cmp_eq_u32 s68, 7
    s_cbranch_scc1 L_v_init
    s_cmp_eq_u32 s68, 6
    s_cbranch_scc1 L_v6
    s_mul_i32 s78, s70, 37
    s_lshr_b32 s65, s78, 8
    s_mul_i32 s78, s65, 7
    s_sub_u32 s79, s70, s78
    s_sub_u32 s64, s69, 1
    s_cmp_ge_u32 s70, 28
    s_cselect_b32 s65, s79, s65
    s_cselect_b32 s79, s64, s79
    s_cselect_b32 s64, 7, s64
    s_lshl3_add_u32 s70, s65, s64
    s_mul_i32 s76, s79, 37
    s_min_u32 s76, s76, 221
    s_lshl_b32 s78, s70, 10
    s_add_u32 s76, s76, s78
    s_and_b32 s81, s68, 3
    s_add_u32 s76, s76, s81
    s_addk_i32 s76, 768
    s_lshl_b32 s76, s76, 12
    s_lshl1_add_u32 s66, s65, s64
    s_lshl_b32 s66, s66, 14
    s_cmp_ge_u32 s68, 4
    s_cbranch_scc1 L_qside
    v_lshlrev_b32 v4, 2, v3
    v_xor_b32 v4, v4, v1
    v_lshlrev_b32 v4, 4, v4
    v_xor_b32 v5, 16, v4
    v_xor_b32 v6, 32, v4
    v_xor_b32 v7, 48, v4
    s_sub_u32 s78, 3, s68
    s_mul_i32 m0, s78, 0x9000
    s_and_b32 s80, s66, 0x1ffff
    s_add_u32 s80, s80, s76
    s_lshl_b32 s46, 1, 27
    s_mov_b32 s47, 0x20000
    s_waitcnt lgkmcnt(0)
    s_mov_b64 s[44:45], s[6:7]
    buffer_load_dwordx4 v4, s[44:47], s80 offen offset:0 nt lds
    buffer_load_dwordx4 v5, s[44:47], s80 offen offset:1024 nt lds
    buffer_load_dwordx4 v6, s[44:47], s80 offen offset:2048 nt lds
    buffer_load_dwordx4 v7, s[44:47], s80 offen offset:3072 nt lds
    s_branch L_k_more
L_tail:
    v_and_b32 v2, 15, v0
    s_and_b32 s3, s68, 3
    s_cmp_ge_u32 s68, 4
    s_cbranch_scc1 L_gwave
    s_lshl_b32 s76, s3, 13
    s_add_u32 s76, s76, 131072
    v_lshlrev_b32 v12, 2, v3
    v_xor_b32 v12, v12, v2
    v_lshlrev_b32 v12, 4, v12
    v_lshl_add_u32 v8, v3, 10, v12
    s_lshl_b32 s78, s3, 8
    v_add_u32 v8, s78, v8
    v_add_u32 v9, 3072, v8
    v_add_u32 v10, 6144, v8
    v_add_u32 v11, 9216, v8
    s_lshl_b32 s80, s70, 17
    s_lshl_b32 s75, s70, 16
    s_and_b32 s78, s70, 7
    s_lshl_b32 s78, s78, 14
    s_add_u32 s80, s80, s78
    s_and_b32 s78, s78, 0xc000
    s_add_u32 s75, s75, s78
    s_lshl_b32 s73, s3, 14
    s_add_u32 s73, s73, 65536
    s_waitcnt lgkmcnt(0)
    s_mov_b32 s44, s12
    s_mov_b32 s45, s13
    s_mov_b32 s46, 0x400000
    s_mov_b32 s47, 0x20000
    s_add_u32 m0, s76, 0
    s_xor_b32 s79, s80, 0
    buffer_load_dwordx4 v8, s[44:47], s79 offen offset:0 nt lds
    buffer_load_dwordx4 v9, s[44:47], s79 offen offset:1024 nt lds
    buffer_load_dwordx4 v10, s[44:47], s79 offen offset:2048 nt lds
    buffer_load_dwordx4 v11, s[44:47], s79 offen offset:3072 nt lds
    s_add_u32 m0, s76, 4096
    s_xor_b32 s79, s80, 16384
    buffer_load_dwordx4 v8, s[44:47], s79 offen offset:0 nt lds
    buffer_load_dwordx4 v9, s[44:47], s79 offen offset:1024 nt lds
    buffer_load_dwordx4 v10, s[44:47], s79 offen offset:2048 nt lds
    buffer_load_dwordx4 v11, s[44:47], s79 offen offset:3072 nt lds
    s_branch L_o_more
L_qside:
    v_and_b32 v2, 15, v0
    s_max_u32 s78, s79, 4
    s_sub_u32 s77, 41, s78
    s_cmp_eq_u32 s79, 6
    s_cselect_b32 s78, 5, 4
    s_cmp_le_u32 s68, s78
    s_cbranch_scc1 L_qjob
    s_waitcnt lgkmcnt(0)
    s_barrier
    s_branch L_v_warm
L_qjob:
    s_setprio 3
    s_add_u32 s78, s79, s68
    s_sub_u32 s78, s78, 4
    s_lshl_b32 s78, s78, 2
    s_lshr_b32 s3, 0x10376542, s78
    s_and_b32 s3, s3, 7
    v_lshrrev_b32 v4, 2, v2
    v_lshlrev_b32 v4, 10, v4
    v_and_b32 v5, 3, v2
    v_lshl_add_u32 v4, v5, 4, v4
    v_lshl_add_u32 v4, v3, 6, v4
    s_add_u32 s56, s65, 0
    s_and_b32 s56, s56, 3
    s_lshl_b32 s56, s56, 8
    s_add_u32 s57, s65, 1
    s_and_b32 s57, s57, 3
    s_lshl_b32 s57, s57, 8
    s_add_u32 s58, s65, 2
    s_and_b32 s58, s58, 3
    s_lshl_b32 s58, s58, 8
    s_add_u32 s59, s65, 3
    s_and_b32 s59, s59, 3
    s_lshl_b32 s59, s59, 8
    v_lshlrev_b32 v5, 18, v3
    v_lshrrev_b32 v7, 3, v2
    v_lshl_add_u32 v5, v7, 16, v5
    v_and_b32 v6, 7, v2
    v_lshl_add_u32 v5, v6, 4, v5
    s_lshl_b32 s78, s3, 7
    s_lshl_b32 s79, s64, 10
    s_add_u32 s78, s78, s79
    s_lshl_b32 s79, s65, 20
    s_add_u32 s44, s78, s79
    s_add_u32 s45, s44, 8192
    s_add_u32 s46, s44, 16384
    s_add_u32 s47, s44, 24576
    s_add_u32 s48, s44, 32768
    s_add_u32 s49, s44, 40960
    s_add_u32 s50, s44, 49152
    s_add_u32 s51, s44, 57344
    v_add_u32 v10, 0x20000, v5
    s_lshl_b32 s60, s64, 15
    s_lshl_b32 s80, s65, 13
    s_add_u32 s60, s60, s80
    s_lshl_b32 s80, s3, 10
    s_add_u32 s60, s60, s80
    v_lshlrev_b32 v6, 4, v2
    v_lshl_add_u32 v6, v3, 8, v6
    s_waitcnt lgkmcnt(0)
    s_mov_b32 s28, s4
    s_mov_b32 s29, s5
    s_mov_b32 s30, 0x1000
    s_mov_b32 s31, 0x20000
    s_mov_b32 s32, s10
    s_mov_b32 s33, s11
    s_mov_b32 s34, 0x400000
    s_mov_b32 s35, 0x20000
    buffer_load_dwordx4 v[16:19], v4, s[28:31], s56 offen
    buffer_load_dwordx4 v[20:23], v4, s[28:31], s57 offen
    buffer_load_dwordx4 v[24:27], v4, s[28:31], s58 offen
    buffer_load_dwordx4 v[28:31], v4, s[28:31], s59 offen
    buffer_load_dwordx4 v[64:67], v5, s[32:35], s44 offen nt
    buffer_load_dwordx4 v[68:71], v5, s[32:35], s45 offen nt
    buffer_load_dwordx4 v[72:75], v5, s[32:35], s46 offen nt
    buffer_load_dwordx4 v[76:79], v5, s[32:35], s47 offen nt
    buffer_load_dwordx4 v[80:83], v5, s[32:35], s48 offen nt
    buffer_load_dwordx4 v[84:87], v5, s[32:35], s49 offen nt
    buffer_load_dwordx4 v[88:91], v5, s[32:35], s50 offen nt
    buffer_load_dwordx4 v[92:95], v5, s[32:35], s51 offen nt
    buffer_load_dwordx4 v[96:99], v10, s[32:35], s44 offen nt
    buffer_load_dwordx4 v[100:103], v10, s[32:35], s45 offen nt
    buffer_load_dwordx4 v[104:107], v10, s[32:35], s46 offen nt
    buffer_load_dwordx4 v[108:111], v10, s[32:35], s47 offen nt
    buffer_load_dwordx4 v[112:115], v10, s[32:35], s48 offen nt
    buffer_load_dwordx4 v[116:119], v10, s[32:35], s49 offen nt
    buffer_load_dwordx4 v[120:123], v10, s[32:35], s50 offen nt
    buffer_load_dwordx4 v[124:127], v10, s[32:35], s51 offen nt
    s_barrier
    s_branch L_q_body
    .org sequential_preLN__sliding_block_cached__swiglu_ffn__decode_kernel + 0x440, 0
L_v_init:
    v_mov_b32 v8, -1
    v_mov_b32 v9, -1
    v_mov_b32 v10, -1
    v_mov_b32 v11, -1
    v_lshlrev_b32 v6, 4, v1
    v_add_u32 v7, 151552, v6
    ds_write_b128 v7, v[8:11]
    ds_write_b128 v7, v[8:11] offset:1024
    s_waitcnt lgkmcnt(0)
    s_barrier
    s_branch L_v_late
L_k_more:
    s_mov_b32 s75, m0
    s_max_u32 s78, s79, 4
    s_sub_u32 s77, 41, s78
    s_sub_u32 s77, s77, s68
    s_add_u32 s77, s77, 3
    s_lshr_b32 s77, s77, 2
    s_lshl_b32 s73, s77, 14
    s_movk_i32 s72, 0x4000
    s_load_dword s85, s[26:27], 532480
L_k_loop:
    s_add_u32 m0, m0, 4096
    s_add_u32 s80, s66, s72
    s_and_b32 s80, s80, 0x1ffff
    s_bitcmp1_b32 s72, 17
    s_cselect_b32 s80, s72, s80
    s_add_u32 s80, s80, s76
    s_waitcnt vmcnt(4)
    buffer_load_dwordx4 v4, s[44:47], s80 offen offset:0 nt lds
    buffer_load_dwordx4 v5, s[44:47], s80 offen offset:1024 nt lds
    buffer_load_dwordx4 v6, s[44:47], s80 offen offset:2048 nt lds
    buffer_load_dwordx4 v7, s[44:47], s80 offen offset:3072 nt lds
    s_cmp_lg_u32 s72, 16384
    s_cbranch_scc1 L_k_nobar
    s_barrier
L_k_nobar:
    s_addk_i32 s72, 0x4000
    s_cmp_lt_u32 s72, s73
    s_cbranch_scc1 L_k_loop
    s_mov_b32 s36, s26
    s_mov_b32 s37, s27
    s_mov_b32 s38, 0x240000
    s_mov_b32 s39, 0x20000
    v_and_b32 v2, 15, v0
    v_lshlrev_b32 v61, 4, v2
    v_lshrrev_b32 v62, 5, v1
    v_lshl_add_u32 v61, v62, 13, v61
    v_and_b32 v62, 1, v3
    v_lshl_add_u32 v61, v62, 10, v61
    s_lshl_b32 s84, s70, 3
    s_add_u32 s84, s84, s79
    s_lshl_b32 s54, s64, 15
    s_lshl_b32 s78, s65, 8
    s_add_u32 s54, s54, s78
    s_lshl_b32 s78, s68, 11
    s_add_u32 s54, s54, s78
    s_add_u32 s52, s54, 1835008
    s_cmp_eq_u32 s64, 7
    s_cselect_b32 s54, s52, s54
    s_add_u32 s55, s54, 16384
    buffer_load_dwordx4 v[160:163], v61, s[36:39], s54 offen sc1
    buffer_load_dwordx4 v[164:167], v61, s[36:39], s55 offen sc1
    s_barrier
    v_mov_b32 v255, 0xff
    s_mov_b32 s71, 262144
    s_mov_b32 s40, s26
    s_mov_b32 s41, s27
    s_mov_b32 s42, 0x240000
    s_mov_b32 s43, 0x20000
    s_mul_i32 s84, s84, 4096
    s_add_u32 s84, s84, 540672
    s_waitcnt lgkmcnt(0)
    s_add_u32 s85, s85, 0x9e3779b1
    s_bfe_u32 s12, s85, 0x80000
    s_bfe_u32 s13, s85, 0x80008
    s_bfe_u32 s14, s85, 0x80010
    s_bfe_u32 s15, s85, 0x80018
    v_and_b32 v62, 3, v2
    v_lshlrev_b32 v12, 4, v62
    v_lshlrev_b32 v62, 10, v62
    v_lshrrev_b32 v63, 2, v2
    v_lshl_add_u32 v62, v63, 8, v62
    v_xor_b32 v14, v3, v2
    v_lshl_add_u32 v62, v14, 4, v62
    v_xor_b32 v8, 0, v62
    v_add_u32 v8, s75, v8
    v_xor_b32 v9, 64, v62
    v_add_u32 v9, s75, v9
    v_xor_b32 v10, 128, v62
    v_add_u32 v10, s75, v10
    v_xor_b32 v11, 192, v62
    v_add_u32 v11, s75, v11
    v_add_u32 v13, 152576, v12
    v_lshl_add_u32 v12, v3, 6, v12
    v_lshrrev_b32 v14, 1, v63
    v_lshl_add_u32 v44, v14, 10, v12
    v_and_b32 v14, 1, v63
    v_lshl_add_u32 v44, v14, 3, v44
    s_lshl_b32 s80, s68, 8
    s_add_u32 s80, s80, 153600
    v_add_u32 v44, s80, v44
    v_add_u32 v12, 151552, v12
    v_add_u32 v62, 8, v63
    v_cmp_gt_u32 s[18:19], s77, v62
    s_mov_b32 s4, 0xf000f
    s_mov_b32 s5, 0xf000f
    s_mov_b32 s6, 0xf000f0
    s_mov_b32 s7, 0xf000f0
    s_mov_b32 s8, 0xf000f00
    s_mov_b32 s9, 0xf000f00
    s_mov_b32 s10, 0xf000f000
    s_mov_b32 s11, 0xf000f000
    v_mov_b64 v[64:65], 0
    v_mov_b64 v[66:67], 0
    v_mov_b64 v[68:69], 0
    v_mov_b64 v[70:71], 0
    v_mov_b64 v[72:73], 0
    v_mov_b64 v[74:75], 0
    v_mov_b64 v[76:77], 0
    v_mov_b64 v[78:79], 0
    v_mov_b64 v[80:81], 0
    v_mov_b64 v[82:83], 0
    v_mov_b64 v[84:85], 0
    v_mov_b64 v[86:87], 0
    v_mov_b64 v[88:89], 0
    v_mov_b64 v[90:91], 0
    v_mov_b64 v[92:93], 0
    v_mov_b64 v[94:95], 0
    v_mov_b64 v[96:97], 0
    v_mov_b64 v[98:99], 0
    v_mov_b64 v[100:101], 0
    v_mov_b64 v[102:103], 0
    v_mov_b64 v[104:105], 0
    v_mov_b64 v[106:107], 0
    v_mov_b64 v[108:109], 0
    v_mov_b64 v[110:111], 0
    v_mov_b64 v[112:113], 0
    v_mov_b64 v[114:115], 0
    v_mov_b64 v[116:117], 0
    v_mov_b64 v[118:119], 0
    v_mov_b64 v[120:121], 0
    v_mov_b64 v[122:123], 0
    v_mov_b64 v[124:125], 0
    v_mov_b64 v[126:127], 0
    s_getreg_b32 s56, hwreg(HW_REG_XCC_ID, 0, 3)
    s_cmp_eq_u32 s64, 7
    s_cselect_b32 s56, 0, s56
    s_xor_b32 s56, s56, s15
    v_and_b32 v16, 7, v1
    v_lshlrev_b32 v16, 6, v16
    v_bfe_u32 v62, v1, 4, 1
    v_lshl_add_u32 v16, v62, 9, v16
    v_and_b32 v62, 8, v1
    v_add_u32 v16, v16, v62
    s_lshl_b32 s80, s68, 4
    s_add_u32 s80, s80, 151552
    v_add_u32 v16, s80, v16
    s_waitcnt vmcnt(0)
    v_xor_b32 v160, s12, v160
    v_xor_b32 v161, s13, v161
    v_xor_b32 v162, s14, v162
    v_xor_b32 v163, s56, v163
    v_xor_b32 v164, s12, v164
    v_xor_b32 v165, s13, v165
    v_xor_b32 v166, s14, v166
    v_xor_b32 v167, s56, v167
    v_or_b32 v62, v160, v161
    v_or3_b32 v62, v62, v162, v163
    v_or3_b32 v62, v62, v164, v165
    v_or3_b32 v62, v62, v166, v167
    v_cmp_ne_u32_sdwa vcc, v62, 0 src0_sel:BYTE_0 src1_sel:DWORD
    s_cbranch_vccnz L_k_q_late
L_k_gathered:
    v_permlane32_swap_b32 v160, v164
    v_permlane32_swap_b32 v161, v165
    v_permlane32_swap_b32 v162, v166
    v_permlane32_swap_b32 v163, v167
    v_pk_add_f32 v[160:161], v[160:161], v[164:165]
    v_pk_add_f32 v[162:163], v[162:163], v[166:167]
    v_mov_b32 v164, v160
    v_mov_b32 v165, v161
    v_mov_b32 v166, v162
    v_mov_b32 v167, v163
    v_permlane32_swap_b32 v160, v164
    v_permlane32_swap_b32 v161, v165
    v_permlane32_swap_b32 v162, v166
    v_permlane32_swap_b32 v163, v167
    v_pk_add_f32 v[160:161], v[160:161], v[164:165]
    v_pk_add_f32 v[162:163], v[162:163], v[166:167]
    v_cvt_pk_bf16_f32 v160, v160, v161
    v_min_u32 v160, -2, v160
    v_cvt_pk_bf16_f32 v161, v162, v163
    v_min_u32 v161, -2, v161
    ds_write_b64 v16, v[160:161]
    s_mov_b32 s72, 0
L_poll_1:
    ds_read_b128 v[16:19], v12 offset:0
    ds_read_b128 v[20:23], v12 offset:256
    ds_read_b128 v[24:27], v12 offset:512
    ds_read_b128 v[28:31], v12 offset:768
    s_add_u32 s72, s72, 1
    s_cmp_ge_u32 s72, s71
    s_waitcnt lgkmcnt(0)
    v_max_u32 v62, v16, v17
    v_max3_u32 v62, v62, v18, v19
    v_max3_u32 v62, v62, v20, v21
    v_max3_u32 v62, v62, v22, v23
    v_max3_u32 v62, v62, v24, v25
    v_max3_u32 v62, v62, v26, v27
    v_max3_u32 v62, v62, v28, v29
    v_max3_u32 v62, v62, v30, v31
    v_cmp_eq_u32 vcc, -1, v62
    s_cbranch_scc1 L_polled_2
    s_cbranch_vccz L_polled_2
    s_sleep 2
    s_branch L_poll_1
L_polled_2:
    s_mov_b64 exec, s[4:5]
    ds_read_b128 v[64:67], v12 offset:0
    ds_read_b128 v[68:71], v12 offset:256
    ds_read_b128 v[72:75], v12 offset:512
    ds_read_b128 v[76:79], v12 offset:768
    s_mov_b64 exec, s[6:7]
    ds_read_b128 v[80:83], v12 offset:0
    ds_read_b128 v[84:87], v12 offset:256
    ds_read_b128 v[88:91], v12 offset:512
    ds_read_b128 v[92:95], v12 offset:768
    s_waitcnt lgkmcnt(0)
    s_mov_b64 exec, s[8:9]
    ds_read_b128 v[96:99], v12 offset:0
    ds_read_b128 v[100:103], v12 offset:256
    ds_read_b128 v[104:107], v12 offset:512
    ds_read_b128 v[108:111], v12 offset:768
    s_mov_b64 exec, s[10:11]
    ds_read_b128 v[112:115], v12 offset:0
    ds_read_b128 v[116:119], v12 offset:256
    ds_read_b128 v[120:123], v12 offset:512
    ds_read_b128 v[124:127], v12 offset:768
    s_waitcnt lgkmcnt(0)
    s_mov_b64 exec, -1
    s_waitcnt vmcnt(0)
    ds_read_b128 v[128:131], v8 offset:0
    ds_read_b128 v[132:135], v9 offset:0
    ds_read_b128 v[136:139], v10 offset:0
    ds_read_b128 v[140:143], v11 offset:0
    ds_read_b128 v[144:147], v8 offset:4096
    ds_read_b128 v[148:151], v9 offset:4096
    ds_read_b128 v[152:155], v10 offset:4096
    ds_read_b128 v[156:159], v11 offset:4096
    s_waitcnt lgkmcnt(4)
    v_mfma_f32_16x16x32_bf16 v[32:35], v[128:131], v[64:67], 0
    v_mfma_f32_16x16x32_bf16 v[32:35], v[132:135], v[68:71], v[32:35]
    v_mfma_f32_16x16x32_bf16 v[32:35], v[136:139], v[72:75], v[32:35]
    v_mfma_f32_16x16x32_bf16 v[32:35], v[140:143], v[76:79], v[32:35]
    ds_read_b128 v[128:131], v8 offset:8192
    ds_read_b128 v[132:135], v9 offset:8192
    ds_read_b128 v[136:139], v10 offset:8192
    ds_read_b128 v[140:143], v11 offset:8192
    s_waitcnt lgkmcnt(4)
    v_mfma_f32_16x16x32_bf16 v[32:35], v[144:147], v[80:83], v[32:35]
    v_mfma_f32_16x16x32_bf16 v[32:35], v[148:151], v[84:87], v[32:35]
    v_mfma_f32_16x16x32_bf16 v[32:35], v[152:155], v[88:91], v[32:35]
    v_mfma_f32_16x16x32_bf16 v[32:35], v[156:159], v[92:95], v[32:35]
    ds_read_b128 v[144:147], v8 offset:12288
    ds_read_b128 v[148:151], v9 offset:12288
    ds_read_b128 v[152:155], v10 offset:12288
    ds_read_b128 v[156:159], v11 offset:12288
    s_waitcnt lgkmcnt(4)
    v_mfma_f32_16x16x32_bf16 v[32:35], v[128:131], v[96:99], v[32:35]
    v_mfma_f32_16x16x32_bf16 v[32:35], v[132:135], v[100:103], v[32:35]
    v_mfma_f32_16x16x32_bf16 v[32:35], v[136:139], v[104:107], v[32:35]
    v_mfma_f32_16x16x32_bf16 v[32:35], v[140:143], v[108:111], v[32:35]
    ds_read_b128 v[128:131], v8 offset:16384
    ds_read_b128 v[132:135], v9 offset:16384
    ds_read_b128 v[136:139], v10 offset:16384
    ds_read_b128 v[140:143], v11 offset:16384
    s_waitcnt lgkmcnt(4)
    v_mfma_f32_16x16x32_bf16 v[32:35], v[144:147], v[112:115], v[32:35]
    v_mfma_f32_16x16x32_bf16 v[32:35], v[148:151], v[116:119], v[32:35]
    v_mfma_f32_16x16x32_bf16 v[32:35], v[152:155], v[120:123], v[32:35]
    v_mfma_f32_16x16x32_bf16 v[32:35], v[156:159], v[124:127], v[32:35]
    ds_read_b128 v[144:147], v8 offset:20480
    ds_read_b128 v[148:151], v9 offset:20480
    ds_read_b128 v[152:155], v10 offset:20480
    ds_read_b128 v[156:159], v11 offset:20480
    s_waitcnt lgkmcnt(4)
    v_mfma_f32_16x16x32_bf16 v[36:39], v[128:131], v[64:67], 0
    v_mfma_f32_16x16x32_bf16 v[36:39], v[132:135], v[68:71], v[36:39]
    v_mfma_f32_16x16x32_bf16 v[36:39], v[136:139], v[72:75], v[36:39]
    v_mfma_f32_16x16x32_bf16 v[36:39], v[140:143], v[76:79], v[36:39]
    ds_read_b128 v[128:131], v8 offset:24576
    ds_read_b128 v[132:135], v9 offset:24576
    ds_read_b128 v[136:139], v10 offset:24576
    ds_read_b128 v[140:143], v11 offset:24576
    s_waitcnt lgkmcnt(4)
    v_mfma_f32_16x16x32_bf16 v[36:39], v[144:147], v[80:83], v[36:39]
    v_mfma_f32_16x16x32_bf16 v[36:39], v[148:151], v[84:87], v[36:39]
    v_mfma_f32_16x16x32_bf16 v[36:39], v[152:155], v[88:91], v[36:39]
    v_mfma_f32_16x16x32_bf16 v[36:39], v[156:159], v[92:95], v[36:39]
    ds_read_b128 v[144:147], v8 offset:28672
    ds_read_b128 v[148:151], v9 offset:28672
    ds_read_b128 v[152:155], v10 offset:28672
    ds_read_b128 v[156:159], v11 offset:28672
    s_waitcnt lgkmcnt(4)
    v_mfma_f32_16x16x32_bf16 v[36:39], v[128:131], v[96:99], v[36:39]
    v_mfma_f32_16x16x32_bf16 v[36:39], v[132:135], v[100:103], v[36:39]
    v_mfma_f32_16x16x32_bf16 v[36:39], v[136:139], v[104:107], v[36:39]
    v_mfma_f32_16x16x32_bf16 v[36:39], v[140:143], v[108:111], v[36:39]
    ds_read_b128 v[128:131], v8 offset:32768
    ds_read_b128 v[132:135], v9 offset:32768
    ds_read_b128 v[136:139], v10 offset:32768
    ds_read_b128 v[140:143], v11 offset:32768
    s_waitcnt lgkmcnt(4)
    v_mfma_f32_16x16x32_bf16 v[36:39], v[144:147], v[112:115], v[36:39]
    v_mfma_f32_16x16x32_bf16 v[36:39], v[148:151], v[116:119], v[36:39]
    v_mfma_f32_16x16x32_bf16 v[36:39], v[152:155], v[120:123], v[36:39]
    v_mfma_f32_16x16x32_bf16 v[36:39], v[156:159], v[124:127], v[36:39]
    s_cmp_le_u32 s77, 8
    s_cbranch_scc1 L_qk_done
    ds_read_b128 v[144:147], v8 offset:36864
    ds_read_b128 v[148:151], v9 offset:36864
    ds_read_b128 v[152:155], v10 offset:36864
    ds_read_b128 v[156:159], v11 offset:36864
    s_waitcnt lgkmcnt(4)
    v_mfma_f32_16x16x32_bf16 v[40:43], v[128:131], v[64:67], 0
    v_mfma_f32_16x16x32_bf16 v[40:43], v[132:135], v[68:71], v[40:43]
    v_mfma_f32_16x16x32_bf16 v[40:43], v[136:139], v[72:75], v[40:43]
    v_mfma_f32_16x16x32_bf16 v[40:43], v[140:143], v[76:79], v[40:43]
    s_cmp_le_u32 s77, 9
    s_cbranch_scc1 L_qk_done
    s_waitcnt lgkmcnt(0)
    v_mfma_f32_16x16x32_bf16 v[40:43], v[144:147], v[80:83], v[40:43]
    v_mfma_f32_16x16x32_bf16 v[40:43], v[148:151], v[84:87], v[40:43]
    v_mfma_f32_16x16x32_bf16 v[40:43], v[152:155], v[88:91], v[40:43]
    v_mfma_f32_16x16x32_bf16 v[40:43], v[156:159], v[92:95], v[40:43]
    s_branch L_qk_done
    .p2align 12
L_v6:
    s_waitcnt lgkmcnt(0)
    s_barrier
L_v_late:
    v_and_b32 v2, 15, v0
    s_mul_i32 s78, s70, 37
    s_lshr_b32 s65, s78, 8
    s_mul_i32 s78, s65, 7
    s_sub_u32 s79, s70, s78
    s_sub_u32 s64, s69, 1
    s_cmp_ge_u32 s70, 28
    s_cselect_b32 s65, s79, s65
    s_cselect_b32 s79, s64, s79
    s_cselect_b32 s64, 7, s64
    s_lshl3_add_u32 s70, s65, s64
    s_mul_i32 s76, s79, 37
    s_min_u32 s76, s76, 221
    s_lshl_b32 s78, s70, 10
    s_add_u32 s76, s76, s78
    s_and_b32 s81, s68, 3
    s_add_u32 s76, s76, s81
    s_addk_i32 s76, 768
    s_lshl_b32 s76, s76, 12
    s_lshl1_add_u32 s66, s65, s64
    s_lshl_b32 s66, s66, 14
    s_max_u32 s78, s79, 4
    s_sub_u32 s77, 41, s78
L_v_warm:
    s_mov_b64 exec, 0
    s_branch L_warm_q1
L_back_q1:
    s_branch L_warm_q2
L_back_q2:
    s_branch L_warm_v3
L_back_v3:
    s_branch L_warm_v2
L_back_v2:
    s_branch L_warm_v1
L_back_v1:
    s_branch L_warm_k4
L_back_k4:
    s_branch L_warm_k3
L_back_k3:
    s_mov_b64 exec, -1
    s_branch L_vwave
L_q_body:
    s_load_dword s85, s[26:27], 532480
    s_mov_b32 s40, s26
    s_mov_b32 s41, s27
    s_mov_b32 s42, 0x240000
    s_mov_b32 s43, 0x20000
    v_mov_b32 v255, 0xff
    s_mov_b32 s71, 262144
    s_mov_b32 s82, 0x05040100
    s_mov_b32 s83, 0x07060302
    s_mov_b32 s62, 0xff00ff00
    s_mov_b32 s63, 0xff00ff00
    s_waitcnt vmcnt(16)
    v_lshlrev_b32 v32, 16, v16
    v_and_b32 v33, 0xffff0000, v16
    v_lshlrev_b32 v34, 16, v17
    v_and_b32 v35, 0xffff0000, v17
    v_lshlrev_b32 v36, 16, v18
    v_and_b32 v37, 0xffff0000, v18
    v_lshlrev_b32 v38, 16, v19
    v_and_b32 v39, 0xffff0000, v19
    v_lshlrev_b32 v40, 16, v20
    v_and_b32 v41, 0xffff0000, v20
    v_lshlrev_b32 v42, 16, v21
    v_and_b32 v43, 0xffff0000, v21
    v_lshlrev_b32 v44, 16, v22
    v_and_b32 v45, 0xffff0000, v22
    v_lshlrev_b32 v46, 16, v23
    v_and_b32 v47, 0xffff0000, v23
    v_lshlrev_b32 v48, 16, v24
    v_and_b32 v49, 0xffff0000, v24
    v_lshlrev_b32 v50, 16, v25
    v_and_b32 v51, 0xffff0000, v25
    v_lshlrev_b32 v52, 16, v26
    v_and_b32 v53, 0xffff0000, v26
    v_lshlrev_b32 v54, 16, v27
    v_and_b32 v55, 0xffff0000, v27
    v_lshlrev_b32 v56, 16, v28
    v_and_b32 v57, 0xffff0000, v28
    v_lshlrev_b32 v58, 16, v29
    v_and_b32 v59, 0xffff0000, v29
    v_lshlrev_b32 v60, 16, v30
    v_and_b32 v61, 0xffff0000, v30
    v_lshlrev_b32 v62, 16, v31
    v_and_b32 v63, 0xffff0000, v31
    v_pk_add_f32 v[12:13], v[32:33], v[34:35]
    v_pk_add_f32 v[14:15], v[36:37], v[38:39]
    v_pk_add_f32 v[12:13], v[12:13], v[40:41]
    v_pk_add_f32 v[14:15], v[14:15], v[42:43]
    v_pk_add_f32 v[12:13], v[12:13], v[44:45]
    v_pk_add_f32 v[14:15], v[14:15], v[46:47]
    v_pk_add_f32 v[12:13], v[12:13], v[48:49]
    v_pk_add_f32 v[14:15], v[14:15], v[50:51]
    v_pk_add_f32 v[12:13], v[12:13], v[52:53]
    v_pk_add_f32 v[14:15], v[14:15], v[54:55]
    v_pk_add_f32 v[12:13], v[12:13], v[56:57]
    v_pk_add_f32 v[14:15], v[14:15], v[58:59]
    v_pk_add_f32 v[12:13], v[12:13], v[60:61]
    v_pk_add_f32 v[14:15], v[14:15], v[62:63]
    v_pk_add_f32 v[12:13], v[12:13], v[14:15]
    v_add_f32 v12, v12, v13
    s_nop 1
    v_add_f32_dpp v12, v12, v12 quad_perm:[1,0,3,2] row_mask:0xf bank_mask:0xf
    s_nop 1
    v_add_f32_dpp v12, v12, v12 quad_perm:[2,3,0,1] row_mask:0xf bank_mask:0xf
    v_mov_b32 v13, v12
    s_nop 1
    v_permlane32_swap_b32 v12, v13
    v_add_f32 v12, v12, v13
    v_mov_b32 v13, v12
    s_nop 1
    v_permlane16_swap_b32 v12, v13
    v_add_f32 v12, v12, v13
    v_mul_f32 v12, 0x3b000000, v12
    v_mov_b32 v14, 0
    v_mov_b32 v15, 0
    v_pk_add_f32 v[8:9], v[32:33], v[12:13] op_sel_hi:[1,0] neg_lo:[0,1] neg_hi:[0,1]
    v_pk_fma_f32 v[14:15], v[8:9], v[8:9], v[14:15]
    v_pk_add_f32 v[8:9], v[34:35], v[12:13] op_sel_hi:[1,0] neg_lo:[0,1] neg_hi:[0,1]
    v_pk_fma_f32 v[14:15], v[8:9], v[8:9], v[14:15]
    v_pk_add_f32 v[8:9], v[36:37], v[12:13] op_sel_hi:[1,0] neg_lo:[0,1] neg_hi:[0,1]
    v_pk_fma_f32 v[14:15], v[8:9], v[8:9], v[14:15]
    v_pk_add_f32 v[8:9], v[38:39], v[12:13] op_sel_hi:[1,0] neg_lo:[0,1] neg_hi:[0,1]
    v_pk_fma_f32 v[14:15], v[8:9], v[8:9], v[14:15]
    v_pk_add_f32 v[8:9], v[40:41], v[12:13] op_sel_hi:[1,0] neg_lo:[0,1] neg_hi:[0,1]
    v_pk_fma_f32 v[14:15], v[8:9], v[8:9], v[14:15]
    v_pk_add_f32 v[8:9], v[42:43], v[12:13] op_sel_hi:[1,0] neg_lo:[0,1] neg_hi:[0,1]
    v_pk_fma_f32 v[14:15], v[8:9], v[8:9], v[14:15]
    v_pk_add_f32 v[8:9], v[44:45], v[12:13] op_sel_hi:[1,0] neg_lo:[0,1] neg_hi:[0,1]
    v_pk_fma_f32 v[14:15], v[8:9], v[8:9], v[14:15]
    v_pk_add_f32 v[8:9], v[46:47], v[12:13] op_sel_hi:[1,0] neg_lo:[0,1] neg_hi:[0,1]
    v_pk_fma_f32 v[14:15], v[8:9], v[8:9], v[14:15]
    v_pk_add_f32 v[8:9], v[48:49], v[12:13] op_sel_hi:[1,0] neg_lo:[0,1] neg_hi:[0,1]
    v_pk_fma_f32 v[14:15], v[8:9], v[8:9], v[14:15]
    v_pk_add_f32 v[8:9], v[50:51], v[12:13] op_sel_hi:[1,0] neg_lo:[0,1] neg_hi:[0,1]
    v_pk_fma_f32 v[14:15], v[8:9], v[8:9], v[14:15]
    v_pk_add_f32 v[8:9], v[52:53], v[12:13] op_sel_hi:[1,0] neg_lo:[0,1] neg_hi:[0,1]
    v_pk_fma_f32 v[14:15], v[8:9], v[8:9], v[14:15]
    v_pk_add_f32 v[8:9], v[54:55], v[12:13] op_sel_hi:[1,0] neg_lo:[0,1] neg_hi:[0,1]
    v_pk_fma_f32 v[14:15], v[8:9], v[8:9], v[14:15]
    v_pk_add_f32 v[8:9], v[56:57], v[12:13] op_sel_hi:[1,0] neg_lo:[0,1] neg_hi:[0,1]
    v_pk_fma_f32 v[14:15], v[8:9], v[8:9], v[14:15]
    v_pk_add_f32 v[8:9], v[58:59], v[12:13] op_sel_hi:[1,0] neg_lo:[0,1] neg_hi:[0,1]
    v_pk_fma_f32 v[14:15], v[8:9], v[8:9], v[14:15]
    v_pk_add_f32 v[8:9], v[60:61], v[12:13] op_sel_hi:[1,0] neg_lo:[0,1] neg_hi:[0,1]
    v_pk_fma_f32 v[14:15], v[8:9], v[8:9], v[14:15]
    v_pk_add_f32 v[8:9], v[62:63], v[12:13] op_sel_hi:[1,0] neg_lo:[0,1] neg_hi:[0,1]
    v_pk_fma_f32 v[14:15], v[8:9], v[8:9], v[14:15]
    v_add_f32 v14, v14, v15
    s_nop 1
    v_add_f32_dpp v14, v14, v14 quad_perm:[1,0,3,2] row_mask:0xf bank_mask:0xf
    s_nop 1
    v_add_f32_dpp v14, v14, v14 quad_perm:[2,3,0,1] row_mask:0xf bank_mask:0xf
    v_mov_b32 v15, v14
    s_nop 1
    v_permlane32_swap_b32 v14, v15
    v_add_f32 v14, v14, v15
    v_mov_b32 v15, v14
    s_nop 1
    v_permlane16_swap_b32 v14, v15
    v_add_f32 v14, v14, v15
    v_mul_f32 v14, 0x3b000000, v14
    v_cvt_pk_bf16_f32 v12, v12, v12
    v_lshlrev_b32 v12, 16, v12
    v_cvt_pk_bf16_f32 v14, v14, v14
    v_lshlrev_b32 v14, 16, v14
    v_add_f32 v14, 0x3727c5ac, v14
    v_cvt_pk_bf16_f32 v14, v14, v14
    v_lshlrev_b32 v14, 16, v14
    v_sqrt_f32 v14, v14
    s_nop 0
    v_cvt_pk_bf16_f32 v14, v14, v14
    v_lshlrev_b32 v14, 16, v14
    v_rcp_f32 v14, v14
L_warm_q1:
    s_cbranch_execz L_back_q1
    v_pk_add_f32 v[32:33], v[32:33], v[12:13] op_sel_hi:[1,0] neg_lo:[0,1] neg_hi:[0,1]
    v_cvt_pk_bf16_f32 v33, v32, v33
    v_lshlrev_b32 v32, 16, v33
    v_and_b32 v33, 0xffff0000, v33
    v_pk_mul_f32 v[32:33], v[32:33], v[14:15] op_sel_hi:[1,0]
    v_cvt_pk_bf16_f32 v16, v32, v33
    v_pk_add_f32 v[34:35], v[34:35], v[12:13] op_sel_hi:[1,0] neg_lo:[0,1] neg_hi:[0,1]
    v_cvt_pk_bf16_f32 v35, v34, v35
    v_lshlrev_b32 v34, 16, v35
    v_and_b32 v35, 0xffff0000, v35
    v_pk_mul_f32 v[34:35], v[34:35], v[14:15] op_sel_hi:[1,0]
    v_cvt_pk_bf16_f32 v17, v34, v35
    v_pk_add_f32 v[36:37], v[36:37], v[12:13] op_sel_hi:[1,0] neg_lo:[0,1] neg_hi:[0,1]
    v_cvt_pk_bf16_f32 v37, v36, v37
    v_lshlrev_b32 v36, 16, v37
    v_and_b32 v37, 0xffff0000, v37
    v_pk_mul_f32 v[36:37], v[36:37], v[14:15] op_sel_hi:[1,0]
    v_cvt_pk_bf16_f32 v18, v36, v37
    v_pk_add_f32 v[38:39], v[38:39], v[12:13] op_sel_hi:[1,0] neg_lo:[0,1] neg_hi:[0,1]
    v_cvt_pk_bf16_f32 v39, v38, v39
    v_lshlrev_b32 v38, 16, v39
    v_and_b32 v39, 0xffff0000, v39
    v_pk_mul_f32 v[38:39], v[38:39], v[14:15] op_sel_hi:[1,0]
    v_cvt_pk_bf16_f32 v19, v38, v39
    s_waitcnt vmcnt(8)
    v_perm_b32 v128, v68, v64, s82
    v_perm_b32 v129, v76, v72, s82
    v_perm_b32 v130, v84, v80, s82
    v_perm_b32 v131, v92, v88, s82
    v_perm_b32 v132, v68, v64, s83
    v_perm_b32 v133, v76, v72, s83
    v_perm_b32 v134, v84, v80, s83
    v_perm_b32 v135, v92, v88, s83
    v_mfma_f32_16x16x32_bf16 v[160:163], v[16:19], v[128:131], 0
    v_perm_b32 v136, v69, v65, s82
    v_perm_b32 v137, v77, v73, s82
    v_perm_b32 v138, v85, v81, s82
    v_perm_b32 v139, v93, v89, s82
    v_mfma_f32_16x16x32_bf16 v[164:167], v[16:19], v[132:135], 0
    v_perm_b32 v140, v69, v65, s83
    v_perm_b32 v141, v77, v73, s83
    v_perm_b32 v142, v85, v81, s83
    v_perm_b32 v143, v93, v89, s83
    v_mfma_f32_16x16x32_bf16 v[168:171], v[16:19], v[136:139], 0
    v_perm_b32 v144, v70, v66, s82
    v_perm_b32 v145, v78, v74, s82
    v_perm_b32 v146, v86, v82, s82
    v_perm_b32 v147, v94, v90, s82
    v_mfma_f32_16x16x32_bf16 v[172:175], v[16:19], v[140:143], 0
    v_perm_b32 v148, v70, v66, s83
    v_perm_b32 v149, v78, v74, s83
    v_perm_b32 v150, v86, v82, s83
    v_perm_b32 v151, v94, v90, s83
    v_mfma_f32_16x16x32_bf16 v[176:179], v[16:19], v[144:147], 0
    v_perm_b32 v152, v71, v67, s82
    v_perm_b32 v153, v79, v75, s82
    v_perm_b32 v154, v87, v83, s82
    v_perm_b32 v155, v95, v91, s82
    v_mfma_f32_16x16x32_bf16 v[180:183], v[16:19], v[148:151], 0
    v_perm_b32 v156, v71, v67, s83
    v_perm_b32 v157, v79, v75, s83
    v_perm_b32 v158, v87, v83, s83
    v_perm_b32 v159, v95, v91, s83
    v_mfma_f32_16x16x32_bf16 v[184:187], v[16:19], v[152:155], 0
    s_nop 0
    v_mfma_f32_16x16x32_bf16 v[188:191], v[16:19], v[156:159], 0
L_warm_q2:
    s_cbranch_execz L_back_q2
    s_waitcnt vmcnt(0)
    v_perm_b32 v128, v100, v96, s82
    v_perm_b32 v129, v108, v104, s82
    v_perm_b32 v130, v116, v112, s82
    v_perm_b32 v131, v124, v120, s82
    v_perm_b32 v132, v100, v96, s83
    v_perm_b32 v133, v108, v104, s83
    v_perm_b32 v134, v116, v112, s83
    v_perm_b32 v135, v124, v120, s83
    v_mfma_f32_16x16x32_bf16 v[192:195], v[16:19], v[128:131], 0
    v_perm_b32 v136, v101, v97, s82
    v_perm_b32 v137, v109, v105, s82
    v_perm_b32 v138, v117, v113, s82
    v_perm_b32 v139, v125, v121, s82
    v_mfma_f32_16x16x32_bf16 v[196:199], v[16:19], v[132:135], 0
    v_perm_b32 v140, v101, v97, s83
    v_perm_b32 v141, v109, v105, s83
    v_perm_b32 v142, v117, v113, s83
    v_perm_b32 v143, v125, v121, s83
    v_mfma_f32_16x16x32_bf16 v[200:203], v[16:19], v[136:139], 0
    v_perm_b32 v144, v102, v98, s82
    v_perm_b32 v145, v110, v106, s82
    v_perm_b32 v146, v118, v114, s82
    v_perm_b32 v147, v126, v122, s82
    v_mfma_f32_16x16x32_bf16 v[204:207], v[16:19], v[140:143], 0
    v_perm_b32 v148, v102, v98, s83
    v_perm_b32 v149, v110, v106, s83
    v_perm_b32 v150, v118, v114, s83
    v_perm_b32 v151, v126, v122, s83
    v_mfma_f32_16x16x32_bf16 v[208:211], v[16:19], v[144:147], 0
    v_perm_b32 v152, v103, v99, s82
    v_perm_b32 v153, v111, v107, s82
    v_perm_b32 v154, v119, v115, s82
    v_perm_b32 v155, v127, v123, s82
    v_mfma_f32_16x16x32_bf16 v[212:215], v[16:19], v[148:151], 0
    v_perm_b32 v156, v103, v99, s83
    v_perm_b32 v157, v111, v107, s83
    v_perm_b32 v158, v119, v115, s83
    v_perm_b32 v159, v127, v123, s83
    v_mfma_f32_16x16x32_bf16 v[216:219], v[16:19], v[152:155], 0
    s_nop 0
    v_mfma_f32_16x16x32_bf16 v[220:223], v[16:19], v[156:159], 0
    s_waitcnt lgkmcnt(0)
    s_add_u32 s85, s85, 0x9e3779b1
    s_bfe_u32 s12, s85, 0x80000
    s_bfe_u32 s13, s85, 0x80008
    s_bfe_u32 s14, s85, 0x80010
    s_bfe_u32 s15, s85, 0x80018
    v_pk_add_f32 v[160:161], v[160:161], v[194:195]
    v_pk_add_f32 v[164:165], v[164:165], v[198:199]
    v_pk_add_f32 v[168:169], v[168:169], v[202:203]
    v_pk_add_f32 v[172:173], v[172:173], v[206:207]
    v_pk_add_f32 v[176:177], v[176:177], v[210:211]
    v_pk_add_f32 v[180:181], v[180:181], v[214:215]
    v_pk_add_f32 v[184:185], v[184:185], v[218:219]
    v_pk_add_f32 v[188:189], v[188:189], v[222:223]
    v_cndmask_b32 v160, v160, v161, s[62:63]
    v_cndmask_b32 v164, v164, v165, s[62:63]
    v_cndmask_b32 v168, v168, v169, s[62:63]
    v_cndmask_b32 v172, v172, v173, s[62:63]
    v_cndmask_b32 v176, v176, v177, s[62:63]
    v_cndmask_b32 v180, v180, v181, s[62:63]
    v_cndmask_b32 v184, v184, v185, s[62:63]
    v_cndmask_b32 v188, v188, v189, s[62:63]
    v_add_f32_dpp v160, v160, v160 row_ror:8 row_mask:0xf bank_mask:0xf
    v_add_f32_dpp v164, v164, v164 row_ror:8 row_mask:0xf bank_mask:0xf
    v_add_f32_dpp v168, v168, v168 row_ror:8 row_mask:0xf bank_mask:0xf
    v_add_f32_dpp v172, v172, v172 row_ror:8 row_mask:0xf bank_mask:0xf
    v_add_f32_dpp v176, v176, v176 row_ror:8 row_mask:0xf bank_mask:0xf
    v_add_f32_dpp v180, v180, v180 row_ror:8 row_mask:0xf bank_mask:0xf
    v_add_f32_dpp v184, v184, v184 row_ror:8 row_mask:0xf bank_mask:0xf
    v_add_f32_dpp v188, v188, v188 row_ror:8 row_mask:0xf bank_mask:0xf
    v_cndmask_b32 v32, v160, v176, s[62:63]
    v_add_u32 v32, 0x80, v32
    v_cndmask_b32 v33, v164, v180, s[62:63]
    v_add_u32 v33, 0x80, v33
    v_cndmask_b32 v34, v168, v184, s[62:63]
    v_add_u32 v34, 0x80, v34
    v_cndmask_b32 v35, v172, v188, s[62:63]
    v_add_u32 v35, 0x80, v35
    v_bfi_b32 v32, v255, s12, v32
    v_bfi_b32 v33, v255, s13, v33
    v_bfi_b32 v34, v255, s14, v34
    v_bfi_b32 v35, v255, s15, v35
    s_sub_u32 s78, s68, 4
    s_lshl_b32 s78, s78, 10
    s_add_u32 s78, s78, 158720
    v_add_u32 v7, s78, v6
    ds_write_b128 v7, v[32:35]
    s_cmp_eq_u32 s64, 7
    s_cbranch_scc1 L_q_far
    s_getreg_b32 s78, hwreg(HW_REG_XCC_ID, 0, 3)
    v_xor_b32 v39, s78, v35
    v_mov_b32 v36, v32
    v_mov_b32 v37, v33
    v_mov_b32 v38, v34
    buffer_store_dwordx4 v[36:39], v6, s[40:43], s60 offen
    s_branch L_q_sent
L_q_far:
    s_add_u32 s60, s60, 1835008
    buffer_store_dwordx4 v[32:35], v6, s[40:43], s60 offen sc1
L_q_sent:
    s_waitcnt lgkmcnt(0)
    s_setprio 0
    s_branch L_vwave
L_qk_done:
L_warm_k3:
    s_cbranch_execz L_back_k3
    s_mov_b32 s78, 0x3db504f3
    s_mov_b32 s79, 0x3fb8aa3b
    v_mov_b32 v62, 0xff800000
    v_cvt_pk_bf16_f32 v33, v32, v33
    v_lshlrev_b32 v32, 16, v33
    v_and_b32 v33, 0xffff0000, v33
    v_mul_f32 v32, s78, v32
    v_mul_f32 v33, s78, v33
    v_cvt_pk_bf16_f32 v33, v32, v33
    v_lshlrev_b32 v32, 16, v33
    v_and_b32 v33, 0xffff0000, v33
    v_cvt_pk_bf16_f32 v35, v34, v35
    v_lshlrev_b32 v34, 16, v35
    v_and_b32 v35, 0xffff0000, v35
    v_mul_f32 v34, s78, v34
    v_mul_f32 v35, s78, v35
    v_cvt_pk_bf16_f32 v35, v34, v35
    v_lshlrev_b32 v34, 16, v35
    v_and_b32 v35, 0xffff0000, v35
    v_cvt_pk_bf16_f32 v37, v36, v37
    v_lshlrev_b32 v36, 16, v37
    v_and_b32 v37, 0xffff0000, v37
    v_mul_f32 v36, s78, v36
    v_mul_f32 v37, s78, v37
    v_cvt_pk_bf16_f32 v37, v36, v37
    v_lshlrev_b32 v36, 16, v37
    v_and_b32 v37, 0xffff0000, v37
    v_cvt_pk_bf16_f32 v39, v38, v39
    v_lshlrev_b32 v38, 16, v39
    v_and_b32 v39, 0xffff0000, v39
    v_mul_f32 v38, s78, v38
    v_mul_f32 v39, s78, v39
    v_cvt_pk_bf16_f32 v39, v38, v39
    v_lshlrev_b32 v38, 16, v39
    v_and_b32 v39, 0xffff0000, v39
    v_cvt_pk_bf16_f32 v41, v40, v41
    v_lshlrev_b32 v40, 16, v41
    v_and_b32 v41, 0xffff0000, v41
    v_mul_f32 v40, s78, v40
    v_mul_f32 v41, s78, v41
    v_cvt_pk_bf16_f32 v41, v40, v41
    v_lshlrev_b32 v40, 16, v41
    v_and_b32 v41, 0xffff0000, v41
    v_cndmask_b32 v40, v62, v40, s[18:19]
    v_cndmask_b32 v41, v62, v41, s[18:19]
    v_cvt_pk_bf16_f32 v43, v42, v43
    v_lshlrev_b32 v42, 16, v43
    v_and_b32 v43, 0xffff0000, v43
    v_mul_f32 v42, s78, v42
    v_mul_f32 v43, s78, v43
    v_cvt_pk_bf16_f32 v43, v42, v43
    v_lshlrev_b32 v42, 16, v43
    v_and_b32 v43, 0xffff0000, v43
    v_cndmask_b32 v42, v62, v42, s[18:19]
    v_cndmask_b32 v43, v62, v43, s[18:19]
    v_max_f32 v14, v32, v33
    v_max3_f32 v14, v14, v34, v35
    v_max3_f32 v14, v14, v36, v37
    v_max3_f32 v14, v14, v38, v39
    v_max3_f32 v14, v14, v40, v41
    v_max3_f32 v14, v14, v42, v43
    s_nop 1
    v_max_f32_dpp v14, v14, v14 row_ror:8 row_mask:0xf bank_mask:0xf
    s_nop 1
    v_max_f32_dpp v14, v14, v14 row_ror:4 row_mask:0xf bank_mask:0xf
    v_mov_b32 v62, v14
    s_nop 1
    v_permlane32_swap_b32 v14, v62
    v_max_f32 v14, v14, v62
    v_mov_b32 v62, v14
    s_nop 1
    v_permlane16_swap_b32 v14, v62
    v_max_f32 v14, v14, v62
    v_min_u32 v14, -2, v14
    s_lshl_b32 s78, s68, 2
    v_add_u32 v63, s78, v13
    s_mov_b64 exec, 15
    ds_write_b32 v63, v14
    s_mov_b64 exec, -1
    s_mov_b32 s72, 0
L_poll_3:
    ds_read_b128 v[16:19], v13
    s_add_u32 s72, s72, 1
    s_cmp_ge_u32 s72, s71
    s_waitcnt lgkmcnt(0)
    v_max_u32 v62, v16, v17
    v_max3_u32 v62, v62, v18, v19
    v_cmp_eq_u32 vcc, -1, v62
    s_cbranch_scc1 L_polled_4
    s_cbranch_vccz L_polled_4
    s_sleep 1
    s_branch L_poll_3
L_polled_4:
L_warm_k4:
    s_cbranch_execz L_back_k4
    s_nop 0
    v_max_f32 v14, v16, v17
    v_max3_f32 v14, v14, v18, v19
    v_sub_f32 v32, v32, v14
    v_mul_f32 v32, s79, v32
    v_exp_f32 v32, v32
    v_sub_f32 v33, v33, v14
    v_mul_f32 v33, s79, v33
    v_exp_f32 v33, v33
    v_sub_f32 v34, v34, v14
    v_mul_f32 v34, s79, v34
    v_exp_f32 v34, v34
    v_sub_f32 v35, v35, v14
    v_mul_f32 v35, s79, v35
    v_exp_f32 v35, v35
    v_sub_f32 v36, v36, v14
    v_mul_f32 v36, s79, v36
    v_exp_f32 v36, v36
    v_sub_f32 v37, v37, v14
    v_mul_f32 v37, s79, v37
    v_exp_f32 v37, v37
    v_sub_f32 v38, v38, v14
    v_mul_f32 v38, s79, v38
    v_exp_f32 v38, v38
    v_sub_f32 v39, v39, v14
    v_mul_f32 v39, s79, v39
    v_exp_f32 v39, v39
    v_sub_f32 v40, v40, v14
    v_mul_f32 v40, s79, v40
    v_exp_f32 v40, v40
    v_sub_f32 v41, v41, v14
    v_mul_f32 v41, s79, v41
    v_exp_f32 v41, v41
    v_sub_f32 v42, v42, v14
    v_mul_f32 v42, s79, v42
    v_exp_f32 v42, v42
    v_sub_f32 v43, v43, v14
    v_mul_f32 v43, s79, v43
    v_exp_f32 v43, v43
    v_mul_f32 v14, s79, v14
    v_cvt_pk_bf16_f32 v16, v32, v33
    v_cvt_pk_bf16_f32 v17, v34, v35
    v_cvt_pk_bf16_f32 v18, v36, v37
    v_cvt_pk_bf16_f32 v19, v38, v39
    v_cvt_pk_bf16_f32 v20, v40, v41
    v_cvt_pk_bf16_f32 v21, v42, v43
    ds_write_b64 v44, v[16:17]
    ds_write_b64 v44, v[18:19] offset:2048
    s_mov_b32 exec_lo, 0x00ff00ff
    s_mov_b32 exec_hi, 0x00ff00ff
    ds_write_b64 v44, v[20:21] offset:4096
    s_mov_b64 exec, -1
    v_add_f32 v15, v32, v33
    v_add_f32 v15, v15, v34
    v_add_f32 v15, v15, v35
    v_add_f32 v15, v15, v36
    v_add_f32 v15, v15, v37
    v_add_f32 v15, v15, v38
    v_add_f32 v15, v15, v39
    v_add_f32 v15, v15, v40
    v_add_f32 v15, v15, v41
    v_add_f32 v15, v15, v42
    v_add_f32 v15, v15, v43
    s_nop 1
    v_add_f32_dpp v15, v15, v15 row_ror:8 row_mask:0xf bank_mask:0xf
    s_nop 1
    v_add_f32_dpp v15, v15, v15 row_ror:4 row_mask:0xf bank_mask:0xf
    v_mov_b32 v62, v15
    s_nop 1
    v_permlane32_swap_b32 v15, v62
    v_add_f32 v15, v15, v62
    v_mov_b32 v62, v15
    s_nop 1
    v_permlane16_swap_b32 v15, v62
    v_add_f32 v15, v15, v62
    s_mov_b64 exec, 15
    ds_write_b32 v63, v15 offset:64
    s_mov_b64 exec, -1
    s_waitcnt lgkmcnt(0)
    s_barrier
    s_cmp_ge_u32 s68, 2
    s_cbranch_scc1 L_k_lse
    v_and_b32 v10, 127, v0
    v_lshrrev_b32 v8, 5, v10
    v_lshlrev_b32 v11, 1, v8
    v_lshlrev_b32 v8, 4, v8
    v_add_u32 v8, 152640, v8
    ds_read_b128 v[16:19], v8
    v_xor_b32 v11, v11, v10
    v_lshlrev_b32 v11, 4, v11
    v_and_b32 v9, 0x60, v10
    v_add_u32 v10, v10, v9
    v_lshlrev_b32 v10, 4, v10
    s_waitcnt lgkmcnt(0)
    v_add_f32 v16, v16, v17
    v_add_f32 v18, v18, v19
    v_add_f32 v16, v16, v18
    v_rcp_f32 v14, v16
    s_barrier
    s_barrier
    ds_read_b128 v[16:19], v11 offset:0
    ds_read_b128 v[20:23], v11 offset:2048
    ds_read_b128 v[24:27], v11 offset:4096
    ds_read_b128 v[28:31], v11 offset:6144
    s_waitcnt lgkmcnt(2)
    v_pk_add_f32 v[16:17], v[16:17], v[20:21]
    v_pk_add_f32 v[18:19], v[18:19], v[22:23]
    s_waitcnt lgkmcnt(0)
    v_pk_add_f32 v[24:25], v[24:25], v[28:29]
    v_pk_add_f32 v[26:27], v[26:27], v[30:31]
    v_pk_add_f32 v[16:17], v[16:17], v[24:25]
    v_pk_add_f32 v[18:19], v[18:19], v[26:27]
    v_pk_mul_f32 v[16:17], v[16:17], v[14:15] op_sel_hi:[1,0]
    v_pk_mul_f32 v[18:19], v[18:19], v[14:15] op_sel_hi:[1,0]
    v_bfi_b32 v16, v255, s12, v16
    v_bfi_b32 v17, v255, s13, v17
    v_bfi_b32 v18, v255, s14, v18
    v_bfi_b32 v19, v255, s15, v19
    buffer_store_dwordx4 v[16:19], v10, s[40:43], s84 offen offset:512 sc1
    s_branch L_fin
L_k_lse:
    ds_read_b128 v[16:19], v13 offset:64
    v_lshlrev_b32 v62, 3, v1
    v_mov_b32 v15, s85
    s_waitcnt lgkmcnt(0)
    v_add_f32 v16, v16, v17
    v_add_f32 v18, v18, v19
    v_add_f32 v16, v16, v18
    v_log_f32 v16, v16
    s_nop 0
    v_add_f32 v14, v14, v16
    s_mov_b64 exec, 15
    s_cmp_lg_u32 s68, 2
    s_barrier
    s_cbranch_scc1 L_k_idle
    buffer_store_dwordx2 v[14:15], v62, s[40:43], s84 offen sc1
L_k_idle:
    s_mov_b64 exec, -1
    s_barrier
    s_branch L_fin
L_k_q_late:
    s_mov_b32 s72, 0
    s_add_u32 s53, s52, 16384
L_k_q_again:
    buffer_load_dwordx4 v[160:163], v61, s[36:39], s54 offen sc1
    buffer_load_dwordx4 v[164:167], v61, s[36:39], s55 offen sc1
    s_add_u32 s72, s72, 1
    s_waitcnt vmcnt(0)
    v_xor_b32 v160, s12, v160
    v_xor_b32 v161, s13, v161
    v_xor_b32 v162, s14, v162
    v_xor_b32 v163, s56, v163
    v_xor_b32 v164, s12, v164
    v_xor_b32 v165, s13, v165
    v_xor_b32 v166, s14, v166
    v_xor_b32 v167, s56, v167
    v_or_b32 v62, v160, v161
    v_or3_b32 v62, v62, v162, v163
    v_or3_b32 v62, v62, v164, v165
    v_or3_b32 v62, v62, v166, v167
    v_cmp_ne_u32_sdwa vcc, v62, 0 src0_sel:BYTE_0 src1_sel:DWORD
    s_cbranch_vccz L_k_gathered
    s_cmp_lt_u32 s72, 3
    s_cbranch_scc1 L_k_q_again
    s_cmp_lg_u32 s72, 3
    s_cbranch_scc1 L_k_q_resent
    v_lshlrev_b32 v62, 4, v1
    v_add_u32 v168, 158720, v62
    ds_read_b128 v[160:163], v168
    ds_read_b128 v[164:167], v168 offset:1024
    s_lshl_b32 s78, s79, 2
    s_lshr_b32 s78, 0x10376542, s78
    s_and_b32 s78, s78, 7
    s_lshl_b32 s78, s78, 10
    s_lshl_b32 s80, s65, 13
    s_add_u32 s78, s78, s80
    s_lshl_b32 s80, s64, 15
    s_add_u32 s78, s78, s80
    s_add_u32 s78, s78, 1835008
    s_waitcnt lgkmcnt(0)
    buffer_store_dwordx4 v[160:163], v62, s[40:43], s78 offen sc1
    s_cmp_lg_u32 s79, 6
    s_cbranch_scc1 L_k_q_resent
    buffer_store_dwordx4 v[164:167], v62, s[40:43], s78 offen offset:1024 sc1
L_k_q_resent:
    buffer_load_dwordx4 v[160:163], v61, s[36:39], s52 offen sc1
    buffer_load_dwordx4 v[164:167], v61, s[36:39], s53 offen sc1
    s_cmp_lt_u32 s72, s71
    s_waitcnt vmcnt(0)
    v_xor_b32 v160, s12, v160
    v_xor_b32 v161, s13, v161
    v_xor_b32 v162, s14, v162
    v_xor_b32 v163, s15, v163
    v_xor_b32 v164, s12, v164
    v_xor_b32 v165, s13, v165
    v_xor_b32 v166, s14, v166
    v_xor_b32 v167, s15, v167
    v_or_b32 v62, v160, v161
    v_or3_b32 v62, v62, v162, v163
    v_or3_b32 v62, v62, v164, v165
    v_or3_b32 v62, v62, v166, v167
    v_cmp_ne_u32_sdwa vcc, v62, 0 src0_sel:BYTE_0 src1_sel:DWORD
    s_cbranch_vccz L_k_gathered
    s_cbranch_scc1 L_k_q_again
    s_branch L_k_gathered
    .p2align 12
L_vwave:
    s_mov_b32 s48, s8
    s_mov_b32 s49, s9
    s_mov_b32 s50, 0x8000000
    s_mov_b32 s51, 0x20000
    s_mov_b32 s82, 0x05040100
    s_mov_b32 s83, 0x07060302
    v_lshlrev_b32 v4, 4, v1
    s_sub_u32 s81, s68, 4
    v_mov_b32 v80, 0
    v_mov_b32 v81, 0
    v_mov_b32 v82, 0
    v_mov_b32 v83, 0
    v_mov_b32 v84, 0
    v_mov_b32 v85, 0
    v_mov_b32 v86, 0
    v_mov_b32 v87, 0
    v_mov_b32 v88, 0
    v_mov_b32 v89, 0
    v_mov_b32 v90, 0
    v_mov_b32 v91, 0
    v_mov_b32 v92, 0
    v_mov_b32 v93, 0
    v_mov_b32 v94, 0
    v_mov_b32 v95, 0
    v_mov_b32 v96, 0
    v_mov_b32 v97, 0
    v_mov_b32 v98, 0
    v_mov_b32 v99, 0
    v_mov_b32 v100, 0
    v_mov_b32 v101, 0
    v_mov_b32 v102, 0
    v_mov_b32 v103, 0
    v_mov_b32 v104, 0
    v_mov_b32 v105, 0
    v_mov_b32 v106, 0
    v_mov_b32 v107, 0
    v_mov_b32 v108, 0
    v_mov_b32 v109, 0
    v_mov_b32 v110, 0
    v_mov_b32 v111, 0
    s_mov_b32 s4, 0xf000f
    s_mov_b32 s5, 0xf000f
    s_mov_b32 s6, 0xf000f0
    s_mov_b32 s7, 0xf000f0
    s_mov_b32 s8, 0xf000f00
    s_mov_b32 s9, 0xf000f00
    s_mov_b32 s10, 0xf000f000
    s_mov_b32 s11, 0xf000f000
    v_mov_b32 v16, 0
    v_mov_b32 v17, 0
    v_mov_b32 v18, 0
    v_mov_b32 v19, 0
    v_mov_b32 v20, 0
    v_mov_b32 v21, 0
    v_mov_b32 v22, 0
    v_mov_b32 v23, 0
    v_mov_b32 v24, 0
    v_mov_b32 v25, 0
    v_mov_b32 v26, 0
    v_mov_b32 v27, 0
    v_mov_b32 v28, 0
    v_mov_b32 v29, 0
    v_mov_b32 v30, 0
    v_mov_b32 v31, 0
    v_mov_b32 v32, 0
    v_mov_b32 v33, 0
    v_mov_b32 v34, 0
    v_mov_b32 v35, 0
    v_mov_b32 v36, 0
    v_mov_b32 v37, 0
    v_mov_b32 v38, 0
    v_mov_b32 v39, 0
    v_mov_b32 v40, 0
    v_mov_b32 v41, 0
    v_mov_b32 v42, 0
    v_mov_b32 v43, 0
    v_mov_b32 v44, 0
    v_mov_b32 v45, 0
    v_mov_b32 v46, 0
    v_mov_b32 v47, 0
    v_and_b32 v7, 3, v2
    v_lshlrev_b32 v5, 4, v7
    v_lshl_add_u32 v5, v3, 6, v5
    s_lshl_b32 s78, s81, 8
    s_add_u32 s78, s78, 153600
    v_add_u32 v5, s78, v5
    v_lshrrev_b32 v6, 2, v1
    v_lshlrev_b32 v8, 1, v7
    v_xor_b32 v6, v6, v8
    v_lshl_add_u32 v6, v7, 5, v6
    v_lshlrev_b32 v6, 4, v6
    s_lshl_b32 s78, s81, 11
    v_add_u32 v6, s78, v6
    s_barrier
    s_add_u32 s78, s81, 36
    s_cmp_ge_u32 s78, s77
    s_cbranch_scc1 L_v9_done
    s_add_u32 s79, s76, 147456
    buffer_load_dwordx4 v[96:99], v4, s[48:51], s79 offen offset:0 nt
    buffer_load_dwordx4 v[100:103], v4, s[48:51], s79 offen offset:1024 nt
    buffer_load_dwordx4 v[104:107], v4, s[48:51], s79 offen offset:2048 nt
    buffer_load_dwordx4 v[108:111], v4, s[48:51], s79 offen offset:3072 nt
L_v9_done:
    s_add_u32 s78, s81, 32
    s_cmp_ge_u32 s78, s77
    s_cbranch_scc1 L_v8_done
    s_add_u32 s79, s76, 131072
    buffer_load_dwordx4 v[80:83], v4, s[48:51], s79 offen offset:0 nt
    buffer_load_dwordx4 v[84:87], v4, s[48:51], s79 offen offset:1024 nt
    buffer_load_dwordx4 v[88:91], v4, s[48:51], s79 offen offset:2048 nt
    buffer_load_dwordx4 v[92:95], v4, s[48:51], s79 offen offset:3072 nt
L_v8_done:
    s_add_u32 s79, s66, 0
    s_and_b32 s79, s79, 0x1ffff
    s_add_u32 s79, s79, s76
    s_waitcnt vmcnt(2)
    buffer_load_dwordx4 v[112:115], v4, s[48:51], s79 offen offset:0 nt
    buffer_load_dwordx4 v[116:119], v4, s[48:51], s79 offen offset:1024 nt
    buffer_load_dwordx4 v[120:123], v4, s[48:51], s79 offen offset:2048 nt
    buffer_load_dwordx4 v[124:127], v4, s[48:51], s79 offen offset:3072 nt
    v_perm_b32 v50, v100, v96, s82
    v_perm_b32 v51, v108, v104, s82
    v_perm_b32 v54, v100, v96, s83
    v_perm_b32 v55, v108, v104, s83
    v_perm_b32 v58, v101, v97, s82
    v_perm_b32 v59, v109, v105, s82
    v_perm_b32 v62, v101, v97, s83
    v_perm_b32 v63, v109, v105, s83
    v_perm_b32 v66, v102, v98, s82
    v_perm_b32 v67, v110, v106, s82
    v_perm_b32 v70, v102, v98, s83
    v_perm_b32 v71, v110, v106, s83
    v_perm_b32 v74, v103, v99, s82
    v_perm_b32 v75, v111, v107, s82
    v_perm_b32 v78, v103, v99, s83
    v_perm_b32 v79, v111, v107, s83
    s_add_u32 s79, s66, 16384
    s_and_b32 s79, s79, 0x1ffff
    s_add_u32 s79, s79, s76
    s_waitcnt vmcnt(4)
    buffer_load_dwordx4 v[128:131], v4, s[48:51], s79 offen offset:0 nt
    buffer_load_dwordx4 v[132:135], v4, s[48:51], s79 offen offset:1024 nt
    buffer_load_dwordx4 v[136:139], v4, s[48:51], s79 offen offset:2048 nt
    buffer_load_dwordx4 v[140:143], v4, s[48:51], s79 offen offset:3072 nt
    v_perm_b32 v48, v84, v80, s82
    v_perm_b32 v49, v92, v88, s82
    v_perm_b32 v52, v84, v80, s83
    v_perm_b32 v53, v92, v88, s83
    v_perm_b32 v56, v85, v81, s82
    v_perm_b32 v57, v93, v89, s82
    v_perm_b32 v60, v85, v81, s83
    v_perm_b32 v61, v93, v89, s83
    v_perm_b32 v64, v86, v82, s82
    v_perm_b32 v65, v94, v90, s82
    v_perm_b32 v68, v86, v82, s83
    v_perm_b32 v69, v94, v90, s83
    v_perm_b32 v72, v87, v83, s82
    v_perm_b32 v73, v95, v91, s82
    v_perm_b32 v76, v87, v83, s83
    v_perm_b32 v77, v95, v91, s83
L_warm_v1:
    s_cbranch_execz L_back_v1
    s_add_u32 s79, s66, 32768
    s_and_b32 s79, s79, 0x1ffff
    s_add_u32 s79, s79, s76
    s_waitcnt vmcnt(4)
    buffer_load_dwordx4 v[144:147], v4, s[48:51], s79 offen offset:0 nt
    buffer_load_dwordx4 v[148:151], v4, s[48:51], s79 offen offset:1024 nt
    buffer_load_dwordx4 v[152:155], v4, s[48:51], s79 offen offset:2048 nt
    buffer_load_dwordx4 v[156:159], v4, s[48:51], s79 offen offset:3072 nt
    v_perm_b32 v80, v116, v112, s82
    v_perm_b32 v81, v124, v120, s82
    v_perm_b32 v84, v116, v112, s83
    v_perm_b32 v85, v124, v120, s83
    v_perm_b32 v88, v117, v113, s82
    v_perm_b32 v89, v125, v121, s82
    v_perm_b32 v92, v117, v113, s83
    v_perm_b32 v93, v125, v121, s83
    v_perm_b32 v96, v118, v114, s82
    v_perm_b32 v97, v126, v122, s82
    v_perm_b32 v100, v118, v114, s83
    v_perm_b32 v101, v126, v122, s83
    v_perm_b32 v104, v119, v115, s82
    v_perm_b32 v105, v127, v123, s82
    v_perm_b32 v108, v119, v115, s83
    v_perm_b32 v109, v127, v123, s83
    s_add_u32 s79, s66, 49152
    s_and_b32 s79, s79, 0x1ffff
    s_add_u32 s79, s79, s76
    s_waitcnt vmcnt(4)
    buffer_load_dwordx4 v[160:163], v4, s[48:51], s79 offen offset:0 nt
    buffer_load_dwordx4 v[164:167], v4, s[48:51], s79 offen offset:1024 nt
    buffer_load_dwordx4 v[168:171], v4, s[48:51], s79 offen offset:2048 nt
    buffer_load_dwordx4 v[172:175], v4, s[48:51], s79 offen offset:3072 nt
    v_perm_b32 v82, v132, v128, s82
    v_perm_b32 v83, v140, v136, s82
    v_perm_b32 v86, v132, v128, s83
    v_perm_b32 v87, v140, v136, s83
    v_perm_b32 v90, v133, v129, s82
    v_perm_b32 v91, v141, v137, s82
    v_perm_b32 v94, v133, v129, s83
    v_perm_b32 v95, v141, v137, s83
    v_perm_b32 v98, v134, v130, s82
    v_perm_b32 v99, v142, v138, s82
    v_perm_b32 v102, v134, v130, s83
    v_perm_b32 v103, v142, v138, s83
    v_perm_b32 v106, v135, v131, s82
    v_perm_b32 v107, v143, v139, s82
    v_perm_b32 v110, v135, v131, s83
    v_perm_b32 v111, v143, v139, s83
    s_add_u32 s79, s66, 65536
    s_and_b32 s79, s79, 0x1ffff
    s_add_u32 s79, s79, s76
    s_waitcnt vmcnt(4)
    buffer_load_dwordx4 v[176:179], v4, s[48:51], s79 offen offset:0 nt
    buffer_load_dwordx4 v[180:183], v4, s[48:51], s79 offen offset:1024 nt
    buffer_load_dwordx4 v[184:187], v4, s[48:51], s79 offen offset:2048 nt
    buffer_load_dwordx4 v[188:191], v4, s[48:51], s79 offen offset:3072 nt
    v_perm_b32 v112, v148, v144, s82
    v_perm_b32 v113, v156, v152, s82
    v_perm_b32 v116, v148, v144, s83
    v_perm_b32 v117, v156, v152, s83
    v_perm_b32 v120, v149, v145, s82
    v_perm_b32 v121, v157, v153, s82
    v_perm_b32 v124, v149, v145, s83
    v_perm_b32 v125, v157, v153, s83
    v_perm_b32 v128, v150, v146, s82
    v_perm_b32 v129, v158, v154, s82
    v_perm_b32 v132, v150, v146, s83
    v_perm_b32 v133, v158, v154, s83
    v_perm_b32 v136, v151, v147, s82
    v_perm_b32 v137, v159, v155, s82
    v_perm_b32 v140, v151, v147, s83
    v_perm_b32 v141, v159, v155, s83
    s_add_u32 s79, s66, 81920
    s_and_b32 s79, s79, 0x1ffff
    s_add_u32 s79, s79, s76
    s_waitcnt vmcnt(4)
    buffer_load_dwordx4 v[192:195], v4, s[48:51], s79 offen offset:0 nt
    buffer_load_dwordx4 v[196:199], v4, s[48:51], s79 offen offset:1024 nt
    buffer_load_dwordx4 v[200:203], v4, s[48:51], s79 offen offset:2048 nt
    buffer_load_dwordx4 v[204:207], v4, s[48:51], s79 offen offset:3072 nt
    v_perm_b32 v114, v164, v160, s82
    v_perm_b32 v115, v172, v168, s82
    v_perm_b32 v118, v164, v160, s83
    v_perm_b32 v119, v172, v168, s83
    v_perm_b32 v122, v165, v161, s82
    v_perm_b32 v123, v173, v169, s82
    v_perm_b32 v126, v165, v161, s83
    v_perm_b32 v127, v173, v169, s83
    v_perm_b32 v130, v166, v162, s82
    v_perm_b32 v131, v174, v170, s82
    v_perm_b32 v134, v166, v162, s83
    v_perm_b32 v135, v174, v170, s83
    v_perm_b32 v138, v167, v163, s82
    v_perm_b32 v139, v175, v171, s82
    v_perm_b32 v142, v167, v163, s83
    v_perm_b32 v143, v175, v171, s83
    s_add_u32 s79, s66, 98304
    s_and_b32 s79, s79, 0x1ffff
    s_add_u32 s79, s79, s76
    s_waitcnt vmcnt(4)
    buffer_load_dwordx4 v[208:211], v4, s[48:51], s79 offen offset:0 nt
    buffer_load_dwordx4 v[212:215], v4, s[48:51], s79 offen offset:1024 nt
    buffer_load_dwordx4 v[216:219], v4, s[48:51], s79 offen offset:2048 nt
    buffer_load_dwordx4 v[220:223], v4, s[48:51], s79 offen offset:3072 nt
    v_perm_b32 v144, v180, v176, s82
    v_perm_b32 v145, v188, v184, s82
    v_perm_b32 v148, v180, v176, s83
    v_perm_b32 v149, v188, v184, s83
    v_perm_b32 v152, v181, v177, s82
    v_perm_b32 v153, v189, v185, s82
    v_perm_b32 v156, v181, v177, s83
    v_perm_b32 v157, v189, v185, s83
    v_perm_b32 v160, v182, v178, s82
    v_perm_b32 v161, v190, v186, s82
    v_perm_b32 v164, v182, v178, s83
    v_perm_b32 v165, v190, v186, s83
    v_perm_b32 v168, v183, v179, s82
    v_perm_b32 v169, v191, v187, s82
    v_perm_b32 v172, v183, v179, s83
    v_perm_b32 v173, v191, v187, s83
L_warm_v2:
    s_cbranch_execz L_back_v2
    s_add_u32 s79, s66, 114688
    s_and_b32 s79, s79, 0x1ffff
    s_add_u32 s79, s79, s76
    s_waitcnt vmcnt(4)
    buffer_load_dwordx4 v[224:227], v4, s[48:51], s79 offen offset:0 nt
    buffer_load_dwordx4 v[228:231], v4, s[48:51], s79 offen offset:1024 nt
    buffer_load_dwordx4 v[232:235], v4, s[48:51], s79 offen offset:2048 nt
    buffer_load_dwordx4 v[236:239], v4, s[48:51], s79 offen offset:3072 nt
    v_perm_b32 v146, v196, v192, s82
    v_perm_b32 v147, v204, v200, s82
    v_perm_b32 v150, v196, v192, s83
    v_perm_b32 v151, v204, v200, s83
    v_perm_b32 v154, v197, v193, s82
    v_perm_b32 v155, v205, v201, s82
    v_perm_b32 v158, v197, v193, s83
    v_perm_b32 v159, v205, v201, s83
    v_perm_b32 v162, v198, v194, s82
    v_perm_b32 v163, v206, v202, s82
    v_perm_b32 v166, v198, v194, s83
    v_perm_b32 v167, v206, v202, s83
    v_perm_b32 v170, v199, v195, s82
    v_perm_b32 v171, v207, v203, s82
    v_perm_b32 v174, v199, v195, s83
    v_perm_b32 v175, v207, v203, s83
    s_barrier
    s_mov_b64 exec, s[4:5]
    ds_read_b128 v[16:19], v5 offset:4096
    s_mov_b64 exec, s[6:7]
    ds_read_b128 v[20:23], v5 offset:4096
    s_mov_b64 exec, s[8:9]
    ds_read_b128 v[24:27], v5 offset:4096
    s_mov_b64 exec, s[10:11]
    ds_read_b128 v[28:31], v5 offset:4096
    s_mov_b64 exec, -1
    s_mov_b64 exec, s[4:5]
    ds_read_b128 v[32:35], v5 offset:0
    s_mov_b64 exec, s[6:7]
    ds_read_b128 v[36:39], v5 offset:0
    s_mov_b64 exec, s[8:9]
    ds_read_b128 v[40:43], v5 offset:0
    s_mov_b64 exec, s[10:11]
    ds_read_b128 v[44:47], v5 offset:0
    s_mov_b64 exec, -1
    s_waitcnt lgkmcnt(4)
    v_mfma_f32_16x16x32_bf16 v[8:11], v[48:51], v[16:19], 0
    v_mfma_f32_16x16x32_bf16 v[12:15], v[64:67], v[16:19], 0
    v_mfma_f32_16x16x32_bf16 v[8:11], v[52:55], v[20:23], v[8:11]
    v_mfma_f32_16x16x32_bf16 v[12:15], v[68:71], v[20:23], v[12:15]
    v_mfma_f32_16x16x32_bf16 v[8:11], v[56:59], v[24:27], v[8:11]
    v_mfma_f32_16x16x32_bf16 v[12:15], v[72:75], v[24:27], v[12:15]
    v_mfma_f32_16x16x32_bf16 v[8:11], v[60:63], v[28:31], v[8:11]
    v_mfma_f32_16x16x32_bf16 v[12:15], v[76:79], v[28:31], v[12:15]
    s_mov_b64 exec, s[4:5]
    ds_read_b128 v[16:19], v5 offset:1024
    s_mov_b64 exec, s[6:7]
    ds_read_b128 v[20:23], v5 offset:1024
    s_mov_b64 exec, s[8:9]
    ds_read_b128 v[24:27], v5 offset:1024
    s_mov_b64 exec, s[10:11]
    ds_read_b128 v[28:31], v5 offset:1024
    s_mov_b64 exec, -1
    s_waitcnt lgkmcnt(4)
    v_mfma_f32_16x16x32_bf16 v[8:11], v[80:83], v[32:35], v[8:11]
    v_mfma_f32_16x16x32_bf16 v[12:15], v[96:99], v[32:35], v[12:15]
    v_mfma_f32_16x16x32_bf16 v[8:11], v[84:87], v[36:39], v[8:11]
    v_mfma_f32_16x16x32_bf16 v[12:15], v[100:103], v[36:39], v[12:15]
    v_mfma_f32_16x16x32_bf16 v[8:11], v[88:91], v[40:43], v[8:11]
    v_mfma_f32_16x16x32_bf16 v[12:15], v[104:107], v[40:43], v[12:15]
    v_mfma_f32_16x16x32_bf16 v[8:11], v[92:95], v[44:47], v[8:11]
    v_mfma_f32_16x16x32_bf16 v[12:15], v[108:111], v[44:47], v[12:15]
    s_mov_b64 exec, s[4:5]
    ds_read_b128 v[32:35], v5 offset:2048
    s_mov_b64 exec, s[6:7]
    ds_read_b128 v[36:39], v5 offset:2048
    s_mov_b64 exec, s[8:9]
    ds_read_b128 v[40:43], v5 offset:2048
    s_mov_b64 exec, s[10:11]
    ds_read_b128 v[44:47], v5 offset:2048
    s_mov_b64 exec, -1
    s_waitcnt lgkmcnt(4)
    v_mfma_f32_16x16x32_bf16 v[8:11], v[112:115], v[16:19], v[8:11]
    v_mfma_f32_16x16x32_bf16 v[12:15], v[128:131], v[16:19], v[12:15]
    v_mfma_f32_16x16x32_bf16 v[8:11], v[116:119], v[20:23], v[8:11]
    v_mfma_f32_16x16x32_bf16 v[12:15], v[132:135], v[20:23], v[12:15]
    v_mfma_f32_16x16x32_bf16 v[8:11], v[120:123], v[24:27], v[8:11]
    v_mfma_f32_16x16x32_bf16 v[12:15], v[136:139], v[24:27], v[12:15]
    v_mfma_f32_16x16x32_bf16 v[8:11], v[124:127], v[28:31], v[8:11]
    v_mfma_f32_16x16x32_bf16 v[12:15], v[140:143], v[28:31], v[12:15]
L_warm_v3:
    s_cbranch_execz L_back_v3
    s_mov_b64 exec, s[4:5]
    ds_read_b128 v[16:19], v5 offset:3072
    s_mov_b64 exec, s[6:7]
    ds_read_b128 v[20:23], v5 offset:3072
    s_mov_b64 exec, s[8:9]
    ds_read_b128 v[24:27], v5 offset:3072
    s_mov_b64 exec, s[10:11]
    ds_read_b128 v[28:31], v5 offset:3072
    s_mov_b64 exec, -1
    s_waitcnt lgkmcnt(4)
    v_mfma_f32_16x16x32_bf16 v[8:11], v[144:147], v[32:35], v[8:11]
    v_mfma_f32_16x16x32_bf16 v[12:15], v[160:163], v[32:35], v[12:15]
    v_mfma_f32_16x16x32_bf16 v[8:11], v[148:151], v[36:39], v[8:11]
    v_mfma_f32_16x16x32_bf16 v[12:15], v[164:167], v[36:39], v[12:15]
    v_mfma_f32_16x16x32_bf16 v[8:11], v[152:155], v[40:43], v[8:11]
    v_mfma_f32_16x16x32_bf16 v[12:15], v[168:171], v[40:43], v[12:15]
    v_mfma_f32_16x16x32_bf16 v[8:11], v[156:159], v[44:47], v[8:11]
    v_mfma_f32_16x16x32_bf16 v[12:15], v[172:175], v[44:47], v[12:15]
    s_waitcnt vmcnt(5)
    s_barrier
    s_waitcnt vmcnt(4)
    v_perm_b32 v176, v212, v208, s82
    v_perm_b32 v177, v220, v216, s82
    v_perm_b32 v180, v212, v208, s83
    v_perm_b32 v181, v220, v216, s83
    v_perm_b32 v184, v213, v209, s82
    v_perm_b32 v185, v221, v217, s82
    v_perm_b32 v188, v213, v209, s83
    v_perm_b32 v189, v221, v217, s83
    v_perm_b32 v192, v214, v210, s82
    v_perm_b32 v193, v222, v218, s82
    v_perm_b32 v196, v214, v210, s83
    v_perm_b32 v197, v222, v218, s83
    v_perm_b32 v200, v215, v211, s82
    v_perm_b32 v201, v223, v219, s82
    v_perm_b32 v204, v215, v211, s83
    v_perm_b32 v205, v223, v219, s83
    s_waitcnt vmcnt(0) lgkmcnt(0)
    v_perm_b32 v178, v228, v224, s82
    v_perm_b32 v179, v236, v232, s82
    v_perm_b32 v194, v230, v226, s82
    v_perm_b32 v195, v238, v234, s82
    v_mfma_f32_16x16x32_bf16 v[8:11], v[176:179], v[16:19], v[8:11]
    v_perm_b32 v182, v228, v224, s83
    v_perm_b32 v183, v236, v232, s83
    v_mfma_f32_16x16x32_bf16 v[12:15], v[192:195], v[16:19], v[12:15]
    v_perm_b32 v198, v230, v226, s83
    v_perm_b32 v199, v238, v234, s83
    v_mfma_f32_16x16x32_bf16 v[8:11], v[180:183], v[20:23], v[8:11]
    v_perm_b32 v186, v229, v225, s82
    v_perm_b32 v187, v237, v233, s82
    v_mfma_f32_16x16x32_bf16 v[12:15], v[196:199], v[20:23], v[12:15]
    v_perm_b32 v202, v231, v227, s82
    v_perm_b32 v203, v239, v235, s82
    v_mfma_f32_16x16x32_bf16 v[8:11], v[184:187], v[24:27], v[8:11]
    v_perm_b32 v190, v229, v225, s83
    v_perm_b32 v191, v237, v233, s83
    v_mfma_f32_16x16x32_bf16 v[12:15], v[200:203], v[24:27], v[12:15]
    v_perm_b32 v206, v231, v227, s83
    v_perm_b32 v207, v239, v235, s83
    v_mfma_f32_16x16x32_bf16 v[8:11], v[188:191], v[28:31], v[8:11]
    s_nop 0
    v_mfma_f32_16x16x32_bf16 v[12:15], v[204:207], v[28:31], v[12:15]
    s_nop 5
    ds_write_b128 v6, v[8:11]
    s_nop 0
    ds_write_b128 v6, v[12:15] offset:256
    s_waitcnt lgkmcnt(0)
    s_barrier
    s_branch L_fin
    .p2align 12
L_gwave:
    v_lshlrev_b32 v4, 4, v1
    s_getpc_b64 s[80:81]
L_tpc:
    s_mul_i32 s78, s3, 3072
    v_lshl_add_u32 v12, v1, 7, s78
    v_min_u32 v12, L_code_end - L_tpc - 4, v12
    s_cmp_lt_u32 s70, 30
    s_cbranch_scc1 L_no_tpf
    s_mov_b64 exec, 0xffffff
    global_load_dword v253, v12, s[80:81]
    s_mov_b64 exec, -1
L_no_tpf:
    s_lshl_b32 m0, s3, 15
    v_lshrrev_b32 v12, 3, v1
    s_lshl_b32 s78, s3, 7
    v_add_u32 v12, s78, v12
    v_mul_u32_u24 v12, 3584, v12
    v_and_b32 v13, 7, v1
    v_and_b32 v14, 2, v3
    v_xor_b32 v13, v13, v14
    s_and_b32 s78, s3, 1
    s_lshl_b32 s78, s78, 2
    v_xor_b32 v13, s78, v13
    v_lshl_add_u32 v192, v13, 4, v12
    v_add_u32 v193, 26624, v192
    s_lshl_b32 s75, s70, 7
    s_mov_b32 s73, 0
    s_andn2_b32 vcc_lo, 3, s70
    s_mov_b32 vcc_hi, 0
    v_mov_b32 v16, -1
    v_mov_b32 v17, -1
    v_mov_b32 v18, -1
    v_mov_b32 v19, -1
    s_setprio 1
    s_cmp_lt_u32 s70, 28
    s_cselect_b32 s54, 1835008, 0
    s_cselect_b32 s58, 1836032, 0
    s_mov_b32 s55, 0x20000
    s_mov_b32 s59, 0x20000
    s_waitcnt lgkmcnt(0)
    s_mov_b64 s[52:53], s[16:17]
    s_sub_u32 s56, s18, 1024
    s_subb_u32 s57, s19, 0
L_gu_loop:
    s_waitcnt vmcnt(8)
    s_cbranch_vccz L_gu_wide
    s_waitcnt vmcnt(0)
L_gu_wide:
    buffer_load_dwordx4 v192, s[52:55], s75 offen offset:0 nt lds
    buffer_load_dwordx4 v192, s[56:59], s75 offen offset:1024 nt lds
    buffer_load_dwordx4 v193, s[52:55], s75 offen offset:2048 nt lds
    buffer_load_dwordx4 v193, s[56:59], s75 offen offset:3072 nt lds
    s_add_u32 m0, m0, 4096
    s_add_u32 s75, s75, 57344
    s_add_u32 s73, s73, 1
    s_cmp_eq_u32 s73, 1
    s_cbranch_scc1 L_gu_clear
    s_cmp_eq_u32 s73, 3
    s_cbranch_scc1 L_gu_checkin
    s_cmp_eq_u32 s73, 5
    s_cbranch_scc1 L_gu_warm
    s_cmp_lt_u32 s73, 8
    s_cbranch_scc1 L_gu_loop
    s_branch L_g_more
L_gu_warm:
    s_cmp_lg_u32 s3, 0
    s_cbranch_scc1 L_gu_loop
    s_mov_b64 exec, 0
    s_branch L_warm_g3
L_back_g3:
    s_branch L_warm_g2
L_back_g2:
    s_branch L_warm_g1
L_back_g1:
    s_branch L_warm_g0
L_back_g0:
    s_branch L_warm_o0
L_back_o0:
    s_mov_b64 exec, -1
    s_branch L_gu_loop
L_gu_clear:
    s_load_dword s85, s[26:27], 532480
    s_mov_b32 s40, s26
    s_mov_b32 s41, s27
    s_mov_b32 s42, 0x240000
    s_mov_b32 s43, 0x20000
    s_cmp_lg_u32 s3, 3
    s_cbranch_scc1 L_gu_loop
    s_cmp_lt_u32 s70, 28
    s_cbranch_scc1 L_gu_loop
    s_lshl_b32 s78, s70, 10
    s_add_u32 s78, s78, 495616
    buffer_store_dwordx4 v[16:19], v4, s[40:43], s78 offen sc1
    s_waitcnt vmcnt(0) lgkmcnt(0)
    s_add_u32 s79, s85, 0x9e3779b1
    v_mov_b32 v13, s79
    s_lshl_b32 s78, s70, 7
    s_add_u32 s78, s78, 533504
    s_mov_b64 exec, 1
    buffer_store_dword v13, v4, s[40:43], s78 offen sc1
    s_mov_b64 exec, -1
    s_branch L_gu_loop
L_gu_checkin:
    s_cmp_lg_u32 s3, 3
    s_cbranch_scc1 L_gu_loop
    s_getreg_b32 s78, hwreg(HW_REG_XCC_ID, 0, 3)
    v_mov_b32 v12, s78
    s_lshl_b32 s78, s70, 3
    s_add_u32 s78, s78, 536576
    s_waitcnt lgkmcnt(0)
    s_add_u32 s79, s85, 0x9e3779b1
    v_mov_b32 v13, s79
    s_mov_b64 exec, 1
    buffer_store_dwordx2 v[12:13], v4, s[40:43], s78 offen
    s_mov_b64 exec, -1
    s_branch L_gu_loop
L_o_more:
    s_load_dword s85, s[26:27], 532480
    s_mov_b32 s48, s20
    s_mov_b32 s49, s21
    s_mov_b32 s50, 0x1c0000
    s_mov_b32 s51, 0x20000
    s_mov_b32 s36, s26
    s_mov_b32 s37, s27
    s_mov_b32 s38, 0x240000
    s_mov_b32 s39, 0x20000
    s_mov_b32 s40, s26
    s_mov_b32 s41, s27
    s_mov_b32 s42, 0x240000
    s_mov_b32 s43, 0x20000
    v_lshrrev_b32 v12, 2, v2
    v_and_b32 v13, 3, v2
    v_mul_u32_u24 v12, 320, v12
    v_lshl_add_u32 v12, v13, 4, v12
    v_lshl_add_u32 v12, v3, 10, v12
    v_xor_b32 v4, 0, v12
    v_add_u32 v4, s76, v4
    v_xor_b32 v5, 64, v12
    v_add_u32 v5, s76, v5
    v_xor_b32 v6, 128, v12
    v_add_u32 v6, s76, v6
    v_xor_b32 v7, 192, v12
    v_add_u32 v7, s76, v7
    v_bfe_u32 v254, v2, 1, 1
    v_mul_u32_u24 v254, 0xaaaa, v254
    v_add_u32 v254, 0x4444, v254
    v_and_b32 v12, 1, v2
    v_lshlrev_b32 v240, 5, v12
    v_bfe_u32 v12, v2, 2, 1
    v_lshl_add_u32 v240, v12, 6, v240
    v_and_b32 v12, 1, v3
    v_lshl_add_u32 v240, v12, 4, v240
    v_lshrrev_b32 v12, 1, v3
    v_lshl_add_u32 v240, v12, 7, v240
    v_bfe_u32 v12, v2, 1, 1
    v_lshl_add_u32 v240, v12, 8, v240
    s_lshl_b32 s78, s3, 16
    s_lshl_b32 s79, s70, 6
    s_add_u32 s78, s78, s79
    v_lshlrev_b32 v241, 4, v13
    v_bfe_u32 v12, v2, 2, 1
    v_lshl_add_u32 v241, v12, 11, v241
    v_and_b32 v12, 1, v3
    v_lshl_add_u32 v241, v12, 12, v241
    v_lshrrev_b32 v12, 3, v2
    v_lshl_add_u32 v241, v12, 13, v241
    v_lshrrev_b32 v12, 1, v3
    v_lshl_add_u32 v241, v12, 14, v241
    v_add_u32 v241, s78, v241
    s_mov_b32 s16, 262144
    s_mov_b32 s17, 294912
    v_mov_b32 v16, 0
    v_mov_b32 v17, 0
    v_mov_b32 v18, 0
    v_mov_b32 v19, 0
    v_mov_b32 v20, 0
    v_mov_b32 v21, 0
    v_mov_b32 v22, 0
    v_mov_b32 v23, 0
    v_mov_b32 v24, 0
    v_mov_b32 v25, 0
    v_mov_b32 v26, 0
    v_mov_b32 v27, 0
    v_mov_b32 v28, 0
    v_mov_b32 v29, 0
    v_mov_b32 v30, 0
    v_mov_b32 v31, 0
    v_mov_b32 v32, 0
    v_mov_b32 v33, 0
    v_mov_b32 v34, 0
    v_mov_b32 v35, 0
    v_mov_b32 v36, 0
    v_mov_b32 v37, 0
    v_mov_b32 v38, 0
    v_mov_b32 v39, 0
    v_mov_b32 v40, 0
    v_mov_b32 v41, 0
    v_mov_b32 v42, 0
    v_mov_b32 v43, 0
    v_mov_b32 v44, 0
    v_mov_b32 v45, 0
    v_mov_b32 v46, 0
    v_mov_b32 v47, 0
    v_mov_b32 v246, 0
    v_mov_b32 v247, 0
    v_mov_b32 v248, 0
    v_mov_b32 v249, 0
    v_mov_b32 v250, 0
    v_mov_b32 v251, 0
    v_mov_b32 v252, 0
    v_mov_b32 v253, 0
    v_mov_b32 v255, 0xff
    s_mov_b32 s71, 262144
    s_getreg_b32 s74, hwreg(HW_REG_XCC_ID, 0, 3)
    s_waitcnt lgkmcnt(0)
    s_add_u32 s85, s85, 0x9e3779b1
    s_bfe_u32 s12, s85, 0x80000
    s_bfe_u32 s13, s85, 0x80008
    s_bfe_u32 s14, s85, 0x80010
    s_bfe_u32 s15, s85, 0x80018
    s_add_u32 s78, s85, 0x9e3779b1
    s_bfe_u32 s64, s78, 0x80000
    s_bfe_u32 s65, s78, 0x80008
    s_bfe_u32 s66, s78, 0x80010
    s_bfe_u32 s67, s78, 0x80018
    s_mov_b32 s8, 0x00ff00ff
    s_mov_b32 s9, 0x00ff00ff
    s_not_b64 s[10:11], s[8:9]
    s_waitcnt vmcnt(4) lgkmcnt(0)
    ds_read_b64_tr_b16 v[48:49], v4 offset:0
    ds_read_b64_tr_b16 v[56:57], v4 offset:8
    ds_read_b64_tr_b16 v[64:65], v5 offset:0
    ds_read_b64_tr_b16 v[72:73], v5 offset:8
    ds_read_b64_tr_b16 v[80:81], v6 offset:0
    ds_read_b64_tr_b16 v[88:89], v6 offset:8
    ds_read_b64_tr_b16 v[96:97], v7 offset:0
    ds_read_b64_tr_b16 v[104:105], v7 offset:8
    s_waitcnt lgkmcnt(0)
    s_andn2_b32 s78, 3, s70
    s_cbranch_scc0 L_o_wide0
    s_waitcnt vmcnt(0)
L_o_wide0:
    s_add_u32 m0, s76, 0
    s_xor_b32 s79, s80, 32768
    buffer_load_dwordx4 v8, s[44:47], s79 offen offset:0 nt lds
    buffer_load_dwordx4 v9, s[44:47], s79 offen offset:1024 nt lds
    buffer_load_dwordx4 v10, s[44:47], s79 offen offset:2048 nt lds
    buffer_load_dwordx4 v11, s[44:47], s79 offen offset:3072 nt lds
    s_waitcnt vmcnt(4) lgkmcnt(0)
    ds_read_b64_tr_b16 v[50:51], v4 offset:4096
    ds_read_b64_tr_b16 v[58:59], v4 offset:4104
    ds_read_b64_tr_b16 v[66:67], v5 offset:4096
    ds_read_b64_tr_b16 v[74:75], v5 offset:4104
    ds_read_b64_tr_b16 v[82:83], v6 offset:4096
    ds_read_b64_tr_b16 v[90:91], v6 offset:4104
    ds_read_b64_tr_b16 v[98:99], v7 offset:4096
    ds_read_b64_tr_b16 v[106:107], v7 offset:4104
    s_waitcnt lgkmcnt(0)
    s_andn2_b32 s78, 3, s70
    s_cbranch_scc0 L_o_wide1
    s_waitcnt vmcnt(0)
L_o_wide1:
    s_add_u32 m0, s76, 4096
    s_xor_b32 s79, s80, 49152
    buffer_load_dwordx4 v8, s[44:47], s79 offen offset:0 nt lds
    buffer_load_dwordx4 v9, s[44:47], s79 offen offset:1024 nt lds
    buffer_load_dwordx4 v10, s[44:47], s79 offen offset:2048 nt lds
    buffer_load_dwordx4 v11, s[44:47], s79 offen offset:3072 nt lds
    s_waitcnt vmcnt(4) lgkmcnt(0)
    ds_read_b64_tr_b16 v[52:53], v4 offset:0
    ds_read_b64_tr_b16 v[60:61], v4 offset:8
    ds_read_b64_tr_b16 v[68:69], v5 offset:0
    ds_read_b64_tr_b16 v[76:77], v5 offset:8
    ds_read_b64_tr_b16 v[84:85], v6 offset:0
    ds_read_b64_tr_b16 v[92:93], v6 offset:8
    ds_read_b64_tr_b16 v[100:101], v7 offset:0
    ds_read_b64_tr_b16 v[108:109], v7 offset:8
    s_waitcnt lgkmcnt(0)
    s_andn2_b32 s78, 3, s70
    s_cbranch_scc0 L_o_wide2
    s_waitcnt vmcnt(0)
L_o_wide2:
    s_add_u32 m0, s76, 0
    s_xor_b32 s79, s80, 65536
    buffer_load_dwordx4 v8, s[44:47], s79 offen offset:0 nt lds
    buffer_load_dwordx4 v9, s[44:47], s79 offen offset:1024 nt lds
    buffer_load_dwordx4 v10, s[44:47], s79 offen offset:2048 nt lds
    buffer_load_dwordx4 v11, s[44:47], s79 offen offset:3072 nt lds
    s_waitcnt vmcnt(4) lgkmcnt(0)
    ds_read_b64_tr_b16 v[54:55], v4 offset:4096
    ds_read_b64_tr_b16 v[62:63], v4 offset:4104
    ds_read_b64_tr_b16 v[70:71], v5 offset:4096
    ds_read_b64_tr_b16 v[78:79], v5 offset:4104
    ds_read_b64_tr_b16 v[86:87], v6 offset:4096
    ds_read_b64_tr_b16 v[94:95], v6 offset:4104
    ds_read_b64_tr_b16 v[102:103], v7 offset:4096
    ds_read_b64_tr_b16 v[110:111], v7 offset:4104
    s_waitcnt lgkmcnt(0)
    s_andn2_b32 s78, 3, s70
    s_cbranch_scc0 L_o_wide3
    s_waitcnt vmcnt(0)
L_o_wide3:
    s_add_u32 m0, s76, 4096
    s_xor_b32 s79, s80, 81920
    buffer_load_dwordx4 v8, s[44:47], s79 offen offset:0 nt lds
    buffer_load_dwordx4 v9, s[44:47], s79 offen offset:1024 nt lds
    buffer_load_dwordx4 v10, s[44:47], s79 offen offset:2048 nt lds
    buffer_load_dwordx4 v11, s[44:47], s79 offen offset:3072 nt lds
    s_waitcnt vmcnt(4) lgkmcnt(0)
    ds_read_b64_tr_b16 v[112:113], v4 offset:0
    ds_read_b64_tr_b16 v[120:121], v4 offset:8
    ds_read_b64_tr_b16 v[128:129], v5 offset:0
    ds_read_b64_tr_b16 v[136:137], v5 offset:8
    ds_read_b64_tr_b16 v[144:145], v6 offset:0
    ds_read_b64_tr_b16 v[152:153], v6 offset:8
    ds_read_b64_tr_b16 v[160:161], v7 offset:0
    ds_read_b64_tr_b16 v[168:169], v7 offset:8
    s_waitcnt lgkmcnt(0)
    s_andn2_b32 s78, 3, s70
    s_cbranch_scc0 L_o_wide4
    s_waitcnt vmcnt(0)
L_o_wide4:
    s_add_u32 m0, s76, 0
    s_xor_b32 s79, s80, 98304
    buffer_load_dwordx4 v8, s[44:47], s79 offen offset:0 nt lds
    buffer_load_dwordx4 v9, s[44:47], s79 offen offset:1024 nt lds
    buffer_load_dwordx4 v10, s[44:47], s79 offen offset:2048 nt lds
    buffer_load_dwordx4 v11, s[44:47], s79 offen offset:3072 nt lds
    s_waitcnt vmcnt(4) lgkmcnt(0)
    ds_read_b64_tr_b16 v[114:115], v4 offset:4096
    ds_read_b64_tr_b16 v[122:123], v4 offset:4104
    ds_read_b64_tr_b16 v[130:131], v5 offset:4096
    ds_read_b64_tr_b16 v[138:139], v5 offset:4104
    ds_read_b64_tr_b16 v[146:147], v6 offset:4096
    ds_read_b64_tr_b16 v[154:155], v6 offset:4104
    ds_read_b64_tr_b16 v[162:163], v7 offset:4096
    ds_read_b64_tr_b16 v[170:171], v7 offset:4104
    s_waitcnt lgkmcnt(0)
    s_add_u32 m0, s76, 4096
    s_xor_b32 s79, s80, 114688
    buffer_load_dwordx4 v8, s[44:47], s79 offen offset:0 nt lds
    buffer_load_dwordx4 v9, s[44:47], s79 offen offset:1024 nt lds
    buffer_load_dwordx4 v10, s[44:47], s79 offen offset:2048 nt lds
    buffer_load_dwordx4 v11, s[44:47], s79 offen offset:3072 nt lds
    s_waitcnt vmcnt(4) lgkmcnt(0)
    ds_read_b64_tr_b16 v[116:117], v4 offset:0
    ds_read_b64_tr_b16 v[124:125], v4 offset:8
    ds_read_b64_tr_b16 v[132:133], v5 offset:0
    ds_read_b64_tr_b16 v[140:141], v5 offset:8
    ds_read_b64_tr_b16 v[148:149], v6 offset:0
    ds_read_b64_tr_b16 v[156:157], v6 offset:8
    ds_read_b64_tr_b16 v[164:165], v7 offset:0
    ds_read_b64_tr_b16 v[172:173], v7 offset:8
    s_waitcnt lgkmcnt(0)
    s_add_u32 m0, s76, 0
    s_xor_b32 s79, s75, 0
    buffer_load_dwordx4 v8, s[48:51], s79 offen offset:0 nt lds
    buffer_load_dwordx4 v9, s[48:51], s79 offen offset:1024 nt lds
    buffer_load_dwordx4 v10, s[48:51], s79 offen offset:2048 nt lds
    buffer_load_dwordx4 v11, s[48:51], s79 offen offset:3072 nt lds
    s_waitcnt vmcnt(4) lgkmcnt(0)
    ds_read_b64_tr_b16 v[118:119], v4 offset:4096
    ds_read_b64_tr_b16 v[126:127], v4 offset:4104
    ds_read_b64_tr_b16 v[134:135], v5 offset:4096
    ds_read_b64_tr_b16 v[142:143], v5 offset:4104
    ds_read_b64_tr_b16 v[150:151], v6 offset:4096
    ds_read_b64_tr_b16 v[158:159], v6 offset:4104
    ds_read_b64_tr_b16 v[166:167], v7 offset:4096
    ds_read_b64_tr_b16 v[174:175], v7 offset:4104
    s_waitcnt lgkmcnt(0)
    s_add_u32 m0, s76, 4096
    s_xor_b32 s79, s75, 16384
    buffer_load_dwordx4 v8, s[48:51], s79 offen offset:0 nt lds
    buffer_load_dwordx4 v9, s[48:51], s79 offen offset:1024 nt lds
    buffer_load_dwordx4 v10, s[48:51], s79 offen offset:2048 nt lds
    buffer_load_dwordx4 v11, s[48:51], s79 offen offset:3072 nt lds
    s_barrier
    v_and_b32 v244, 31, v1
    v_lshlrev_b32 v244, 3, v244
    s_mov_b32 s81, 536576
    buffer_load_dwordx2 v[242:243], v244, s[36:39], s81 offen sc1
    s_barrier
    s_add_u32 m0, s73, 8192
    s_xor_b32 s79, s75, 32768
    buffer_load_dwordx4 v8, s[48:51], s79 offen offset:0 nt lds
    buffer_load_dwordx4 v9, s[48:51], s79 offen offset:1024 nt lds
    buffer_load_dwordx4 v10, s[48:51], s79 offen offset:2048 nt lds
    buffer_load_dwordx4 v11, s[48:51], s79 offen offset:3072 nt lds
    s_add_u32 m0, s73, 12288
    s_xor_b32 s79, s75, 49152
    buffer_load_dwordx4 v8, s[48:51], s79 offen offset:0 nt lds
    buffer_load_dwordx4 v9, s[48:51], s79 offen offset:1024 nt lds
    buffer_load_dwordx4 v10, s[48:51], s79 offen offset:2048 nt lds
    buffer_load_dwordx4 v11, s[48:51], s79 offen offset:3072 nt lds
    s_waitcnt vmcnt(8) lgkmcnt(0)
    s_mov_b32 s72, 0
L_checkin_6:
    v_xor_b32 v242, s74, v242
    v_xor_b32 v243, s85, v243
    v_or_b32 v242, v242, v243
    v_cmp_ne_u32 vcc, 0, v242
    s_mov_b32 s78, 1
    s_cbranch_vccz L_near_5
    s_add_u32 s72, s72, 1
    s_cmp_ge_u32 s72, 6
    s_cbranch_scc1 L_far_7
    s_sleep 8
    buffer_load_dwordx2 v[242:243], v244, s[36:39], s81 offen sc1
    s_waitcnt vmcnt(0)
    s_branch L_checkin_6
L_far_7:
    v_and_b32 v244, 3, v1
    v_lshlrev_b32 v244, 7, v244
    s_mov_b32 s72, 0
L_poll_8:
    buffer_load_dword v242, v244, s[36:39], s81 offen offset:512 sc1
    s_add_u32 s72, s72, 1
    s_cmp_ge_u32 s72, s71
    s_waitcnt vmcnt(0)
    v_cmp_ne_u32 vcc, s85, v242
    s_cbranch_scc1 L_polled_9
    s_cbranch_vccz L_polled_9
    s_sleep 8
    s_branch L_poll_8
L_polled_9:
    s_mov_b32 s78, 0
L_near_5:
    s_mov_b32 s74, s78
    s_setprio 1
L_warm_o0:
    s_cbranch_execz L_back_o0
    s_cmp_eq_u32 s74, 0
    s_mov_b64 exec, s[8:9]
    s_cbranch_scc1 L_o_far
    s_barrier
    ds_read_b128 v[16:19], v240 offset:0
    ds_read_b128 v[20:23], v240 offset:1024
    s_mov_b64 exec, s[10:11]
    ds_read_b128 v[24:27], v240 offset:0
    ds_read_b128 v[28:31], v240 offset:1024
    s_mov_b64 exec, -1
    s_waitcnt lgkmcnt(3)
    v_smfmac_f32_16x16x64_bf16 v[32:35], v[16:19], v[48:55], v254
    v_smfmac_f32_16x16x64_bf16 v[36:39], v[16:19], v[56:63], v254
    s_waitcnt lgkmcnt(2)
    v_smfmac_f32_16x16x64_bf16 v[32:35], v[20:23], v[112:119], v254
    v_smfmac_f32_16x16x64_bf16 v[36:39], v[20:23], v[120:127], v254
    s_waitcnt lgkmcnt(1)
    v_smfmac_f32_16x16x64_bf16 v[32:35], v[24:27], v[64:71], v254
    v_smfmac_f32_16x16x64_bf16 v[36:39], v[24:27], v[72:79], v254
    s_waitcnt lgkmcnt(0)
    v_smfmac_f32_16x16x64_bf16 v[32:35], v[28:31], v[128:135], v254
    v_smfmac_f32_16x16x64_bf16 v[36:39], v[28:31], v[136:143], v254
    v_smfmac_f32_16x16x64_bf16 v[40:43], v[16:19], v[80:87], v254
    v_smfmac_f32_16x16x64_bf16 v[44:47], v[16:19], v[88:95], v254
    v_smfmac_f32_16x16x64_bf16 v[40:43], v[20:23], v[144:151], v254
    v_smfmac_f32_16x16x64_bf16 v[44:47], v[20:23], v[152:159], v254
    v_smfmac_f32_16x16x64_bf16 v[40:43], v[24:27], v[96:103], v254
    v_smfmac_f32_16x16x64_bf16 v[44:47], v[24:27], v[104:111], v254
    v_smfmac_f32_16x16x64_bf16 v[40:43], v[28:31], v[160:167], v254
    v_smfmac_f32_16x16x64_bf16 v[44:47], v[28:31], v[168:175], v254
    v_pk_add_f32 v[32:33], v[32:33], v[34:35]
    v_pk_add_f32 v[34:35], v[36:37], v[38:39]
    v_bfi_b32 v32, v255, s12, v32
    v_bfi_b32 v33, v255, s13, v33
    v_bfi_b32 v34, v255, s14, v34
    v_bfi_b32 v35, v255, s15, v35
    buffer_store_dwordx4 v[32:35], v241, s[40:43], s16 offen
    v_pk_add_f32 v[40:41], v[40:41], v[42:43]
    v_pk_add_f32 v[42:43], v[44:45], v[46:47]
    v_bfi_b32 v40, v255, s12, v40
    v_bfi_b32 v41, v255, s13, v41
    v_bfi_b32 v42, v255, s14, v42
    v_bfi_b32 v43, v255, s15, v43
    buffer_store_dwordx4 v[40:43], v241, s[40:43], s17 offen
    s_barrier
    s_waitcnt vmcnt(0)
    ds_read_b64_tr_b16 v[176:177], v4 offset:0
    ds_read_b64_tr_b16 v[184:185], v4 offset:8
    ds_read_b64_tr_b16 v[192:193], v5 offset:0
    ds_read_b64_tr_b16 v[200:201], v5 offset:8
    ds_read_b64_tr_b16 v[208:209], v6 offset:0
    ds_read_b64_tr_b16 v[216:217], v6 offset:8
    ds_read_b64_tr_b16 v[224:225], v7 offset:0
    ds_read_b64_tr_b16 v[232:233], v7 offset:8
    s_waitcnt lgkmcnt(4)
    ds_read_b64_tr_b16 v[178:179], v4 offset:4096
    ds_read_b64_tr_b16 v[186:187], v4 offset:4104
    ds_read_b64_tr_b16 v[194:195], v5 offset:4096
    ds_read_b64_tr_b16 v[202:203], v5 offset:4104
    ds_read_b64_tr_b16 v[210:211], v6 offset:4096
    ds_read_b64_tr_b16 v[218:219], v6 offset:4104
    ds_read_b64_tr_b16 v[226:227], v7 offset:4096
    ds_read_b64_tr_b16 v[234:235], v7 offset:4104
    s_waitcnt lgkmcnt(4)
    s_sub_u32 s78, s73, s76
    v_add_u32 v4, s78, v4
    v_add_u32 v5, s78, v5
    v_add_u32 v6, s78, v6
    v_add_u32 v7, s78, v7
    ds_read_b64_tr_b16 v[180:181], v4 offset:8192
    ds_read_b64_tr_b16 v[188:189], v4 offset:8200
    ds_read_b64_tr_b16 v[196:197], v5 offset:8192
    ds_read_b64_tr_b16 v[204:205], v5 offset:8200
    ds_read_b64_tr_b16 v[212:213], v6 offset:8192
    ds_read_b64_tr_b16 v[220:221], v6 offset:8200
    ds_read_b64_tr_b16 v[228:229], v7 offset:8192
    ds_read_b64_tr_b16 v[236:237], v7 offset:8200
    s_waitcnt lgkmcnt(4)
    ds_read_b64_tr_b16 v[182:183], v4 offset:12288
    ds_read_b64_tr_b16 v[190:191], v4 offset:12296
    ds_read_b64_tr_b16 v[198:199], v5 offset:12288
    ds_read_b64_tr_b16 v[206:207], v5 offset:12296
    ds_read_b64_tr_b16 v[214:215], v6 offset:12288
    ds_read_b64_tr_b16 v[222:223], v6 offset:12296
    ds_read_b64_tr_b16 v[230:231], v7 offset:12288
    ds_read_b64_tr_b16 v[238:239], v7 offset:12296
    s_waitcnt lgkmcnt(4)
    v_mov_b32 v32, 0
    v_mov_b32 v33, 0
    v_mov_b32 v34, 0
    v_mov_b32 v35, 0
    v_mov_b32 v36, 0
    v_mov_b32 v37, 0
    v_mov_b32 v38, 0
    v_mov_b32 v39, 0
    v_mov_b32 v40, 0
    v_mov_b32 v41, 0
    v_mov_b32 v42, 0
    v_mov_b32 v43, 0
    v_mov_b32 v44, 0
    v_mov_b32 v45, 0
    v_mov_b32 v46, 0
    v_mov_b32 v47, 0
    s_mov_b64 exec, s[8:9]
    s_waitcnt lgkmcnt(0)
    s_barrier
    s_barrier
    ds_read_b128 v[246:249], v240 offset:512
    s_mov_b64 exec, s[10:11]
    ds_read_b128 v[250:253], v240 offset:512
    s_mov_b64 exec, -1
    s_waitcnt lgkmcnt(1)
    v_smfmac_f32_16x16x64_bf16 v[32:35], v[246:249], v[176:183], v254
    v_smfmac_f32_16x16x64_bf16 v[36:39], v[246:249], v[184:191], v254
    s_waitcnt lgkmcnt(0)
    v_smfmac_f32_16x16x64_bf16 v[32:35], v[250:253], v[192:199], v254
    v_smfmac_f32_16x16x64_bf16 v[36:39], v[250:253], v[200:207], v254
    v_smfmac_f32_16x16x64_bf16 v[40:43], v[246:249], v[208:215], v254
    v_smfmac_f32_16x16x64_bf16 v[44:47], v[246:249], v[216:223], v254
    v_smfmac_f32_16x16x64_bf16 v[40:43], v[250:253], v[224:231], v254
    v_smfmac_f32_16x16x64_bf16 v[44:47], v[250:253], v[232:239], v254
    s_nop 2
    v_pk_add_f32 v[32:33], v[32:33], v[34:35]
    v_pk_add_f32 v[34:35], v[36:37], v[38:39]
    v_bfi_b32 v32, v255, s64, v32
    v_bfi_b32 v33, v255, s65, v33
    v_bfi_b32 v34, v255, s66, v34
    v_bfi_b32 v35, v255, s67, v35
    buffer_store_dwordx4 v[32:35], v241, s[40:43], s16 offen
    v_pk_add_f32 v[40:41], v[40:41], v[42:43]
    v_pk_add_f32 v[42:43], v[44:45], v[46:47]
    v_bfi_b32 v40, v255, s64, v40
    v_bfi_b32 v41, v255, s65, v41
    v_bfi_b32 v42, v255, s66, v42
    v_bfi_b32 v43, v255, s67, v43
    buffer_store_dwordx4 v[40:43], v241, s[40:43], s17 offen
    s_barrier
    s_branch L_fin
    .p2align 12
L_o_far:
    s_barrier
    ds_read_b128 v[16:19], v240 offset:0
    ds_read_b128 v[20:23], v240 offset:1024
    s_mov_b64 exec, s[10:11]
    ds_read_b128 v[24:27], v240 offset:0
    ds_read_b128 v[28:31], v240 offset:1024
    s_mov_b64 exec, -1
    s_waitcnt lgkmcnt(3)
    v_smfmac_f32_16x16x64_bf16 v[32:35], v[16:19], v[48:55], v254
    v_smfmac_f32_16x16x64_bf16 v[36:39], v[16:19], v[56:63], v254
    s_waitcnt lgkmcnt(2)
    v_smfmac_f32_16x16x64_bf16 v[32:35], v[20:23], v[112:119], v254
    v_smfmac_f32_16x16x64_bf16 v[36:39], v[20:23], v[120:127], v254
    s_waitcnt lgkmcnt(1)
    v_smfmac_f32_16x16x64_bf16 v[32:35], v[24:27], v[64:71], v254
    v_smfmac_f32_16x16x64_bf16 v[36:39], v[24:27], v[72:79], v254
    s_waitcnt lgkmcnt(0)
    v_smfmac_f32_16x16x64_bf16 v[32:35], v[28:31], v[128:135], v254
    v_smfmac_f32_16x16x64_bf16 v[36:39], v[28:31], v[136:143], v254
    v_smfmac_f32_16x16x64_bf16 v[40:43], v[16:19], v[80:87], v254
    v_smfmac_f32_16x16x64_bf16 v[44:47], v[16:19], v[88:95], v254
    v_smfmac_f32_16x16x64_bf16 v[40:43], v[20:23], v[144:151], v254
    v_smfmac_f32_16x16x64_bf16 v[44:47], v[20:23], v[152:159], v254
    v_smfmac_f32_16x16x64_bf16 v[40:43], v[24:27], v[96:103], v254
    v_smfmac_f32_16x16x64_bf16 v[44:47], v[24:27], v[104:111], v254
    v_smfmac_f32_16x16x64_bf16 v[40:43], v[28:31], v[160:167], v254
    v_smfmac_f32_16x16x64_bf16 v[44:47], v[28:31], v[168:175], v254
    v_pk_add_f32 v[32:33], v[32:33], v[34:35]
    v_pk_add_f32 v[34:35], v[36:37], v[38:39]
    v_bfi_b32 v32, v255, s12, v32
    v_bfi_b32 v33, v255, s13, v33
    v_bfi_b32 v34, v255, s14, v34
    v_bfi_b32 v35, v255, s15, v35
    buffer_store_dwordx4 v[32:35], v241, s[40:43], s16 offen sc1
    v_pk_add_f32 v[40:41], v[40:41], v[42:43]
    v_pk_add_f32 v[42:43], v[44:45], v[46:47]
    v_bfi_b32 v40, v255, s12, v40
    v_bfi_b32 v41, v255, s13, v41
    v_bfi_b32 v42, v255, s14, v42
    v_bfi_b32 v43, v255, s15, v43
    buffer_store_dwordx4 v[40:43], v241, s[40:43], s17 offen sc1
    s_barrier
    s_waitcnt vmcnt(0)
    ds_read_b64_tr_b16 v[176:177], v4 offset:0
    ds_read_b64_tr_b16 v[184:185], v4 offset:8
    ds_read_b64_tr_b16 v[192:193], v5 offset:0
    ds_read_b64_tr_b16 v[200:201], v5 offset:8
    ds_read_b64_tr_b16 v[208:209], v6 offset:0
    ds_read_b64_tr_b16 v[216:217], v6 offset:8
    ds_read_b64_tr_b16 v[224:225], v7 offset:0
    ds_read_b64_tr_b16 v[232:233], v7 offset:8
    s_waitcnt lgkmcnt(4)
    ds_read_b64_tr_b16 v[178:179], v4 offset:4096
    ds_read_b64_tr_b16 v[186:187], v4 offset:4104
    ds_read_b64_tr_b16 v[194:195], v5 offset:4096
    ds_read_b64_tr_b16 v[202:203], v5 offset:4104
    ds_read_b64_tr_b16 v[210:211], v6 offset:4096
    ds_read_b64_tr_b16 v[218:219], v6 offset:4104
    ds_read_b64_tr_b16 v[226:227], v7 offset:4096
    ds_read_b64_tr_b16 v[234:235], v7 offset:4104
    s_waitcnt lgkmcnt(4)
    s_sub_u32 s78, s73, s76
    v_add_u32 v4, s78, v4
    v_add_u32 v5, s78, v5
    v_add_u32 v6, s78, v6
    v_add_u32 v7, s78, v7
    ds_read_b64_tr_b16 v[180:181], v4 offset:8192
    ds_read_b64_tr_b16 v[188:189], v4 offset:8200
    ds_read_b64_tr_b16 v[196:197], v5 offset:8192
    ds_read_b64_tr_b16 v[204:205], v5 offset:8200
    ds_read_b64_tr_b16 v[212:213], v6 offset:8192
    ds_read_b64_tr_b16 v[220:221], v6 offset:8200
    ds_read_b64_tr_b16 v[228:229], v7 offset:8192
    ds_read_b64_tr_b16 v[236:237], v7 offset:8200
    s_waitcnt lgkmcnt(4)
    ds_read_b64_tr_b16 v[182:183], v4 offset:12288
    ds_read_b64_tr_b16 v[190:191], v4 offset:12296
    ds_read_b64_tr_b16 v[198:199], v5 offset:12288
    ds_read_b64_tr_b16 v[206:207], v5 offset:12296
    ds_read_b64_tr_b16 v[214:215], v6 offset:12288
    ds_read_b64_tr_b16 v[222:223], v6 offset:12296
    ds_read_b64_tr_b16 v[230:231], v7 offset:12288
    ds_read_b64_tr_b16 v[238:239], v7 offset:12296
    s_waitcnt lgkmcnt(4)
    v_mov_b32 v32, 0
    v_mov_b32 v33, 0
    v_mov_b32 v34, 0
    v_mov_b32 v35, 0
    v_mov_b32 v36, 0
    v_mov_b32 v37, 0
    v_mov_b32 v38, 0
    v_mov_b32 v39, 0
    v_mov_b32 v40, 0
    v_mov_b32 v41, 0
    v_mov_b32 v42, 0
    v_mov_b32 v43, 0
    v_mov_b32 v44, 0
    v_mov_b32 v45, 0
    v_mov_b32 v46, 0
    v_mov_b32 v47, 0
    s_mov_b64 exec, s[8:9]
    s_waitcnt lgkmcnt(0)
    s_barrier
    s_barrier
    ds_read_b128 v[246:249], v240 offset:512
    s_mov_b64 exec, s[10:11]
    ds_read_b128 v[250:253], v240 offset:512
    s_mov_b64 exec, -1
    s_waitcnt lgkmcnt(1)
    v_smfmac_f32_16x16x64_bf16 v[32:35], v[246:249], v[176:183], v254
    v_smfmac_f32_16x16x64_bf16 v[36:39], v[246:249], v[184:191], v254
    s_waitcnt lgkmcnt(0)
    v_smfmac_f32_16x16x64_bf16 v[32:35], v[250:253], v[192:199], v254
    v_smfmac_f32_16x16x64_bf16 v[36:39], v[250:253], v[200:207], v254
    v_smfmac_f32_16x16x64_bf16 v[40:43], v[246:249], v[208:215], v254
    v_smfmac_f32_16x16x64_bf16 v[44:47], v[246:249], v[216:223], v254
    v_smfmac_f32_16x16x64_bf16 v[40:43], v[250:253], v[224:231], v254
    v_smfmac_f32_16x16x64_bf16 v[44:47], v[250:253], v[232:239], v254
    s_nop 2
    v_pk_add_f32 v[32:33], v[32:33], v[34:35]
    v_pk_add_f32 v[34:35], v[36:37], v[38:39]
    v_bfi_b32 v32, v255, s64, v32
    v_bfi_b32 v33, v255, s65, v33
    v_bfi_b32 v34, v255, s66, v34
    v_bfi_b32 v35, v255, s67, v35
    buffer_store_dwordx4 v[32:35], v241, s[40:43], s16 offen sc1
    v_pk_add_f32 v[40:41], v[40:41], v[42:43]
    v_pk_add_f32 v[42:43], v[44:45], v[46:47]
    v_bfi_b32 v40, v255, s64, v40
    v_bfi_b32 v41, v255, s65, v41
    v_bfi_b32 v42, v255, s66, v42
    v_bfi_b32 v43, v255, s67, v43
    buffer_store_dwordx4 v[40:43], v241, s[40:43], s17 offen sc1
    s_barrier
    s_branch L_fin
L_g_more:
    s_mov_b32 s36, s26
    s_mov_b32 s37, s27
    s_mov_b32 s38, 0x240000
    s_mov_b32 s39, 0x20000
    s_mov_b32 s28, s4
    s_mov_b32 s29, s5
    s_mov_b32 s30, 0x1000
    s_mov_b32 s31, 0x20000
    s_mov_b32 s60, s22
    s_mov_b32 s61, s23
    s_mov_b32 s62, 0x1000
    s_mov_b32 s63, 0x20000
    v_mov_b32 v255, 0xff
    s_mov_b32 s71, 262144
    s_getreg_b32 s74, hwreg(HW_REG_XCC_ID, 0, 3)
    s_waitcnt lgkmcnt(0)
    s_add_u32 s85, s85, 0x9e3779b1
    s_bfe_u32 s12, s85, 0x80000
    s_bfe_u32 s13, s85, 0x80008
    s_bfe_u32 s14, s85, 0x80010
    s_bfe_u32 s15, s85, 0x80018
    s_add_u32 s78, s85, 0x9e3779b1
    s_bfe_u32 s64, s78, 0x80000
    s_bfe_u32 s65, s78, 0x80008
    s_bfe_u32 s66, s78, 0x80010
    s_bfe_u32 s67, s78, 0x80018
    s_mov_b32 s8, 0x00ff00ff
    s_mov_b32 s9, 0x00ff00ff
    s_not_b64 s[10:11], s[8:9]
    s_setprio 0
    s_cmp_lt_u32 s70, 28
    s_cbranch_scc1 L_touched
    s_sub_u32 s78, s70, 28
    s_lshl_b32 s78, s78, 2
    s_add_u32 s78, s78, s3
    s_lshl_b32 s78, s78, 14
    s_add_u32 s78, s78, 262144
    buffer_load_dwordx4 v[48:51], v4, s[36:39], s78 offen offset:0 sc1
    buffer_load_dwordx4 v[48:51], v4, s[36:39], s78 offen offset:1024 sc1
    buffer_load_dwordx4 v[48:51], v4, s[36:39], s78 offen offset:2048 sc1
    buffer_load_dwordx4 v[48:51], v4, s[36:39], s78 offen offset:3072 sc1
    s_add_u32 s78, s78, 4096
    buffer_load_dwordx4 v[48:51], v4, s[36:39], s78 offen offset:0 sc1
    buffer_load_dwordx4 v[48:51], v4, s[36:39], s78 offen offset:1024 sc1
    buffer_load_dwordx4 v[48:51], v4, s[36:39], s78 offen offset:2048 sc1
    buffer_load_dwordx4 v[48:51], v4, s[36:39], s78 offen offset:3072 sc1
    s_add_u32 s78, s78, 4096
    buffer_load_dwordx4 v[48:51], v4, s[36:39], s78 offen offset:0 sc1
    buffer_load_dwordx4 v[48:51], v4, s[36:39], s78 offen offset:1024 sc1
    buffer_load_dwordx4 v[48:51], v4, s[36:39], s78 offen offset:2048 sc1
    buffer_load_dwordx4 v[48:51], v4, s[36:39], s78 offen offset:3072 sc1
    s_add_u32 s78, s78, 4096
    buffer_load_dwordx4 v[48:51], v4, s[36:39], s78 offen offset:0 sc1
    buffer_load_dwordx4 v[48:51], v4, s[36:39], s78 offen offset:1024 sc1
    buffer_load_dwordx4 v[48:51], v4, s[36:39], s78 offen offset:2048 sc1
    buffer_load_dwordx4 v[48:51], v4, s[36:39], s78 offen offset:3072 sc1
    s_add_u32 s78, s78, 4096
L_touched:
    s_lshl_b32 s78, s3, 3
    s_lshr_b32 s80, s70, 2
    s_add_u32 s78, s78, s80
    s_mul_i32 s84, s78, 32768
    s_add_u32 s84, s84, 540672
    s_and_b32 s80, s70, 3
    s_lshl_b32 s16, s80, 3
    s_add_u32 s16, s16, s84
    s_lshl_b32 s78, s80, 10
    s_add_u32 s84, s84, s78
    v_mul_u32_u24 v194, 4096, v3
    v_min_u32 v12, 2, v3
    v_add_u32 v12, 4, v12
    v_mul_u32_u24 v195, 4096, v12
    v_lshl_add_u32 v5, v2, 4, v194
    v_lshl_add_u32 v6, v2, 4, v195
    v_lshrrev_b32 v15, 3, v2
    v_lshlrev_b32 v12, 10, v15
    v_bfe_u32 v13, v2, 1, 1
    v_lshlrev_b32 v9, 8, v13
    v_and_b32 v13, 1, v2
    v_lshl_add_u32 v9, v13, 1, v9
    v_add_u32 v12, v12, v9
    v_bfe_u32 v13, v2, 2, 1
    v_lshl_add_u32 v12, v13, 7, v12
    v_lshl_add_u32 v9, v13, 3, v9
    v_lshl_add_u32 v9, v15, 4, v9
    v_lshl_add_u32 v9, v3, 5, v9
    v_and_b32 v13, 1, v3
    v_lshl_add_u32 v12, v13, 4, v12
    v_lshrrev_b32 v14, 1, v3
    v_lshl_add_u32 v12, v14, 2, v12
    s_lshl_b32 s79, s3, 5
    v_add_u32 v7, s79, v12
    s_lshr_b32 s79, s3, 1
    s_and_b32 s80, s3, 1
    s_lshl_b32 s78, s79, 7
    s_lshl_b32 s17, s80, 2
    s_add_u32 s78, s78, s17
    v_add_u32 v9, s78, v9
    s_and_b32 s78, s70, 1
    s_lshl_b32 s78, s78, 2
    s_and_b32 s17, s70, 2
    s_lshl_b32 s17, s17, 6
    s_add_u32 s78, s78, s17
    v_xor_b32 v9, s78, v9
    s_and_b32 s17, s70, 4
    s_lshl_b32 s17, s17, 8
    s_add_u32 s78, s78, s17
    v_xor_b32 v7, s78, v7
    s_lshl_b32 s17, s70, 13
    s_lshl_b32 s78, s3, 11
    s_add_u32 s17, s17, s78
    s_add_u32 s17, s17, 262144
    v_and_b32 v12, 3, v2
    v_lshlrev_b32 v12, 1, v12
    v_lshl_add_u32 v12, v14, 3, v12
    v_lshl_add_u32 v8, v13, 6, v12
    v_lshl_add_u32 v10, v13, 10, v12
    s_and_b32 s78, s70, 7
    s_lshl_b32 s78, s78, 9
    s_lshr_b32 s18, s70, 3
    s_lshl_b32 s18, s18, 4
    s_add_u32 s78, s78, s18
    s_lshl_b32 s18, s80, 8
    s_add_u32 s78, s78, s18
    s_lshl_b32 s18, s79, 7
    s_add_u32 s78, s78, s18
    s_add_u32 s78, s78, 524288
    v_add_u32 v8, s78, v8
    s_lshl_b32 s78, s70, 5
    s_lshl_b32 s18, s80, 4
    s_add_u32 s78, s78, s18
    s_lshl_b32 s18, s79, 11
    s_add_u32 s78, s78, s18
    v_add_u32 v10, s78, v10
    s_lshl_b32 s18, s3, 10
    v_add_u32 v251, s18, v4
    v_xor_b32 v242, 1024, v251
    v_xor_b32 v243, 2048, v251
    v_xor_b32 v244, 3072, v251
    s_add_u32 s18, s18, 524288
    s_lshl_b32 s79, s79, 10
    s_lshl_b32 s80, s80, 3
    s_add_u32 s79, s79, s80
    v_and_b32 v14, 3, v2
    v_lshrrev_b32 v13, 2, v2
    v_lshlrev_b32 v13, 8, v13
    v_lshl_add_u32 v13, v3, 6, v13
    v_lshl_add_u32 v13, v14, 4, v13
    v_add_u32 v252, s79, v13
    v_bfe_u32 v254, v2, 0, 1
    v_mul_u32_u24 v254, 0xaaaa, v254
    v_add_u32 v254, 0x4444, v254
    buffer_load_ushort v11, v10, s[28:31], 0 offen
    v_and_b32 v12, 1, v3
    v_lshl_or_b32 v12, v15, 1, v12
    v_xor_b32 v12, s3, v12
    v_lshlrev_b32 v12, 5, v12
    v_lshl_add_u32 v12, v14, 3, v12
    v_bfe_u32 v13, v2, 2, 1
    v_lshl_add_u32 v12, v13, 7, v12
    v_and_b32 v13, 1, v3
    v_lshl_add_u32 v12, v13, 9, v12
    v_lshrrev_b32 v13, 1, v3
    v_lshl_add_u32 v12, v13, 11, v12
    v_lshl_add_u32 v12, v15, 15, v12
    s_lshl_b32 s78, s3, 13
    v_add_u32 v12, s78, v12
    v_mov_b32 v16, 0x3f803f80
    v_mov_b32 v17, 0x3f803f80
    v_mov_b32 v18, 0x3f803f80
    v_mov_b32 v19, 0x3f803f80
    v_mov_b32 v32, 0
    v_mov_b32 v33, 0
    v_mov_b32 v34, 0
    v_mov_b32 v35, 0
    v_mov_b32 v36, 0
    v_mov_b32 v37, 0
    v_mov_b32 v38, 0
    v_mov_b32 v39, 0
    s_waitcnt vmcnt(0)
    s_barrier
    v_and_b32 v198, 31, v1
    v_lshlrev_b32 v198, 3, v198
    s_mov_b32 s81, 536576
    buffer_load_dwordx2 v[196:197], v198, s[36:39], s81 offen sc1
    v_xor_b32 v13, 0, v12
    ds_read_b64_tr_b16 v[64:65], v13 offset:0
    ds_read_b64_tr_b16 v[66:67], v13 offset:256
    ds_read_b64_tr_b16 v[68:69], v13 offset:4096
    ds_read_b64_tr_b16 v[70:71], v13 offset:4352
    ds_read_b64_tr_b16 v[128:129], v13 offset:1024
    ds_read_b64_tr_b16 v[130:131], v13 offset:1280
    ds_read_b64_tr_b16 v[132:133], v13 offset:5120
    ds_read_b64_tr_b16 v[134:135], v13 offset:5376
    s_waitcnt lgkmcnt(4)
    v_xor_b32 v13, 8192, v12
    ds_read_b64_tr_b16 v[72:73], v13 offset:0
    ds_read_b64_tr_b16 v[74:75], v13 offset:256
    ds_read_b64_tr_b16 v[76:77], v13 offset:4096
    ds_read_b64_tr_b16 v[78:79], v13 offset:4352
    ds_read_b64_tr_b16 v[136:137], v13 offset:1024
    ds_read_b64_tr_b16 v[138:139], v13 offset:1280
    ds_read_b64_tr_b16 v[140:141], v13 offset:5120
    ds_read_b64_tr_b16 v[142:143], v13 offset:5376
    s_waitcnt lgkmcnt(4)
    v_xor_b32 v13, 16384, v12
    ds_read_b64_tr_b16 v[80:81], v13 offset:0
    ds_read_b64_tr_b16 v[82:83], v13 offset:256
    ds_read_b64_tr_b16 v[84:85], v13 offset:4096
    ds_read_b64_tr_b16 v[86:87], v13 offset:4352
    ds_read_b64_tr_b16 v[144:145], v13 offset:1024
    ds_read_b64_tr_b16 v[146:147], v13 offset:1280
    ds_read_b64_tr_b16 v[148:149], v13 offset:5120
    ds_read_b64_tr_b16 v[150:151], v13 offset:5376
    s_waitcnt lgkmcnt(4)
    v_xor_b32 v13, 24576, v12
    ds_read_b64_tr_b16 v[88:89], v13 offset:0
    ds_read_b64_tr_b16 v[90:91], v13 offset:256
    ds_read_b64_tr_b16 v[92:93], v13 offset:4096
    ds_read_b64_tr_b16 v[94:95], v13 offset:4352
    ds_read_b64_tr_b16 v[152:153], v13 offset:1024
    ds_read_b64_tr_b16 v[154:155], v13 offset:1280
    ds_read_b64_tr_b16 v[156:157], v13 offset:5120
    ds_read_b64_tr_b16 v[158:159], v13 offset:5376
    s_waitcnt lgkmcnt(4)
    v_xor_b32 v13, 65536, v12
    ds_read_b64_tr_b16 v[96:97], v13 offset:0
    ds_read_b64_tr_b16 v[98:99], v13 offset:256
    ds_read_b64_tr_b16 v[100:101], v13 offset:4096
    ds_read_b64_tr_b16 v[102:103], v13 offset:4352
    ds_read_b64_tr_b16 v[160:161], v13 offset:1024
    ds_read_b64_tr_b16 v[162:163], v13 offset:1280
    ds_read_b64_tr_b16 v[164:165], v13 offset:5120
    ds_read_b64_tr_b16 v[166:167], v13 offset:5376
    s_waitcnt lgkmcnt(4)
    v_xor_b32 v13, 73728, v12
    ds_read_b64_tr_b16 v[104:105], v13 offset:0
    ds_read_b64_tr_b16 v[106:107], v13 offset:256
    ds_read_b64_tr_b16 v[108:109], v13 offset:4096
    ds_read_b64_tr_b16 v[110:111], v13 offset:4352
    ds_read_b64_tr_b16 v[168:169], v13 offset:1024
    ds_read_b64_tr_b16 v[170:171], v13 offset:1280
    ds_read_b64_tr_b16 v[172:173], v13 offset:5120
    ds_read_b64_tr_b16 v[174:175], v13 offset:5376
    s_waitcnt lgkmcnt(4)
    v_xor_b32 v13, 81920, v12
    ds_read_b64_tr_b16 v[112:113], v13 offset:0
    ds_read_b64_tr_b16 v[114:115], v13 offset:256
    ds_read_b64_tr_b16 v[116:117], v13 offset:4096
    ds_read_b64_tr_b16 v[118:119], v13 offset:4352
    ds_read_b64_tr_b16 v[176:177], v13 offset:1024
    ds_read_b64_tr_b16 v[178:179], v13 offset:1280
    ds_read_b64_tr_b16 v[180:181], v13 offset:5120
    ds_read_b64_tr_b16 v[182:183], v13 offset:5376
    s_waitcnt lgkmcnt(4)
    v_xor_b32 v13, 90112, v12
    ds_read_b64_tr_b16 v[120:121], v13 offset:0
    ds_read_b64_tr_b16 v[122:123], v13 offset:256
    ds_read_b64_tr_b16 v[124:125], v13 offset:4096
    ds_read_b64_tr_b16 v[126:127], v13 offset:4352
    ds_read_b64_tr_b16 v[184:185], v13 offset:1024
    ds_read_b64_tr_b16 v[186:187], v13 offset:1280
    ds_read_b64_tr_b16 v[188:189], v13 offset:5120
    ds_read_b64_tr_b16 v[190:191], v13 offset:5376
    s_waitcnt lgkmcnt(4)
    s_waitcnt lgkmcnt(0)
    s_barrier
    v_smfmac_f32_16x16x64_bf16 v[32:35], v[16:19], v[64:71], v254
    v_smfmac_f32_16x16x64_bf16 v[36:39], v[16:19], v[128:135], v254
    v_smfmac_f32_16x16x64_bf16 v[32:35], v[16:19], v[72:79], v254
    v_smfmac_f32_16x16x64_bf16 v[36:39], v[16:19], v[136:143], v254
    v_smfmac_f32_16x16x64_bf16 v[32:35], v[16:19], v[80:87], v254
    v_smfmac_f32_16x16x64_bf16 v[36:39], v[16:19], v[144:151], v254
    v_smfmac_f32_16x16x64_bf16 v[32:35], v[16:19], v[88:95], v254
    v_smfmac_f32_16x16x64_bf16 v[36:39], v[16:19], v[152:159], v254
    v_smfmac_f32_16x16x64_bf16 v[32:35], v[16:19], v[96:103], v254
    v_smfmac_f32_16x16x64_bf16 v[36:39], v[16:19], v[160:167], v254
    v_smfmac_f32_16x16x64_bf16 v[32:35], v[16:19], v[104:111], v254
    v_smfmac_f32_16x16x64_bf16 v[36:39], v[16:19], v[168:175], v254
    v_smfmac_f32_16x16x64_bf16 v[32:35], v[16:19], v[112:119], v254
    v_smfmac_f32_16x16x64_bf16 v[36:39], v[16:19], v[176:183], v254
    v_smfmac_f32_16x16x64_bf16 v[32:35], v[16:19], v[120:127], v254
    v_smfmac_f32_16x16x64_bf16 v[36:39], v[16:19], v[184:191], v254
    s_waitcnt vmcnt(0)
    s_mov_b32 s72, 0
L_checkin_11:
    v_xor_b32 v196, s74, v196
    v_xor_b32 v197, s85, v197
    v_or_b32 v196, v196, v197
    v_cmp_ne_u32 vcc, 0, v196
    s_mov_b32 s78, 1
    s_cbranch_vccz L_near_10
    s_add_u32 s72, s72, 1
    s_cmp_ge_u32 s72, 6
    s_cbranch_scc1 L_far_12
    s_sleep 8
    buffer_load_dwordx2 v[196:197], v198, s[36:39], s81 offen sc1
    s_waitcnt vmcnt(0)
    s_branch L_checkin_11
L_far_12:
    v_and_b32 v198, 3, v1
    v_lshlrev_b32 v198, 7, v198
    s_mov_b32 s72, 0
L_poll_13:
    buffer_load_dword v196, v198, s[36:39], s81 offen offset:512 sc1
    s_add_u32 s72, s72, 1
    s_cmp_ge_u32 s72, s71
    s_waitcnt vmcnt(0)
    v_cmp_ne_u32 vcc, s85, v196
    s_cbranch_scc1 L_polled_14
    s_cbranch_vccz L_polled_14
    s_sleep 8
    s_branch L_poll_13
L_polled_14:
    s_mov_b32 s78, 0
L_near_10:
    s_mov_b32 s74, s78
    buffer_load_dwordx4 v[208:211], v4, s[36:39], s18 offen sc1
    v_lshlrev_b32 v11, 16, v11
    buffer_store_short v11, v10, s[60:63], 0 offen
    v_add_f32 v248, v32, v33
    v_add_f32 v249, v36, v37
    v_mov_b32 v32, 0
    v_mov_b32 v33, 0
    v_mov_b32 v34, 0
    v_mov_b32 v35, 0
    v_mov_b32 v36, 0
    v_mov_b32 v37, 0
    v_mov_b32 v38, 0
    v_mov_b32 v39, 0
    v_mov_b32 v40, 0
    v_mov_b32 v41, 0
    v_mov_b32 v42, 0
    v_mov_b32 v43, 0
    v_mov_b32 v44, 0
    v_mov_b32 v45, 0
    v_mov_b32 v46, 0
    v_mov_b32 v47, 0
    s_mov_b32 s72, 0
    s_mov_b32 s78, 0x3f803f80
    s_mov_b32 s20, 0x00050005
    s_mov_b32 s21, 0x00050005
    s_mov_b32 s22, 0x3b000000
    s_mov_b32 s23, 0x3b000000
    v_mov_b32 v240, v194
    v_mov_b32 v241, v195
    s_branch L_g_stages
    .p2align 12
L_g_stages:
L_warm_g0:
    s_cbranch_execz L_back_g0
    buffer_load_dwordx2 v[224:225], v240, s[36:39], s16 offen sc1
    buffer_load_dwordx2 v[226:227], v241, s[36:39], s16 offen sc1
    s_sleep 2
L_poll_15:
    buffer_load_dwordx2 v[228:229], v240, s[36:39], s16 offen sc1
    buffer_load_dwordx2 v[230:231], v241, s[36:39], s16 offen sc1
    s_waitcnt vmcnt(2)
    v_mov_b32 v48, v224
    v_mov_b32 v50, v226
    v_xor_b32 v12, s85, v225
    v_xor_b32 v13, s85, v227
    v_or_b32 v12, v12, v13
    v_cmpx_ne_u32 vcc, 0, v12
    s_cbranch_execnz L_more_16
L_polled_17:
    s_mov_b64 exec, -1
    buffer_load_dwordx4 v[192:195], v5, s[36:39], s84 offen offset:512 sc1
    buffer_load_dwordx4 v[196:199], v5, s[36:39], s84 offen offset:768 sc1
    buffer_load_dwordx4 v[200:203], v6, s[36:39], s84 offen offset:512 sc1
    buffer_load_dwordx4 v[204:207], v6, s[36:39], s84 offen offset:768 sc1
    v_max_f32 v12, v48, v50
    v_mov_b32 v13, v12
    s_nop 1
    v_permlane32_swap_b32 v12, v13
    v_max_f32 v12, v12, v13
    v_mov_b32 v13, v12
    s_nop 1
    v_permlane16_swap_b32 v12, v13
    v_max_f32 v12, v12, v13
    v_sub_f32 v48, v48, v12
    v_sub_f32 v50, v50, v12
    v_exp_f32 v48, v48
    v_exp_f32 v50, v50
    v_cmp_eq_u32 vcc, 3, v3
    s_nop 1
    v_cndmask_b32 v50, v50, 0, vcc
    v_add_f32 v12, v48, v50
    v_mov_b32 v13, v12
    s_nop 1
    v_permlane32_swap_b32 v12, v13
    v_add_f32 v12, v12, v13
    v_mov_b32 v13, v12
    s_nop 1
    v_permlane16_swap_b32 v12, v13
    v_add_f32 v12, v12, v13
    v_rcp_f32 v12, v12
    s_nop 0
    v_mul_f32 v14, v50, v12
    v_mul_f32 v12, v48, v12
    s_waitcnt vmcnt(3)
    v_xor_b32 v48, s12, v192
    v_xor_b32 v49, s13, v193
    v_xor_b32 v50, s14, v194
    v_xor_b32 v51, s15, v195
    v_or3_b32 v13, v48, v49, 0
    v_or3_b32 v13, v50, v51, v13
    v_pk_mul_f32 v[48:49], v[48:49], v[12:13] op_sel_hi:[1,0]
    v_pk_mul_f32 v[50:51], v[50:51], v[12:13] op_sel_hi:[1,0]
    s_waitcnt vmcnt(2)
    v_xor_b32 v52, s12, v196
    v_xor_b32 v53, s13, v197
    v_xor_b32 v54, s14, v198
    v_xor_b32 v55, s15, v199
    v_or3_b32 v13, v52, v53, v13
    v_or3_b32 v13, v54, v55, v13
    v_pk_mul_f32 v[52:53], v[52:53], v[12:13] op_sel_hi:[1,0]
    v_pk_mul_f32 v[54:55], v[54:55], v[12:13] op_sel_hi:[1,0]
    s_waitcnt vmcnt(1)
    v_xor_b32 v56, s12, v200
    v_xor_b32 v57, s13, v201
    v_xor_b32 v58, s14, v202
    v_xor_b32 v59, s15, v203
    v_or3_b32 v13, v56, v57, v13
    v_or3_b32 v13, v58, v59, v13
    v_pk_fma_f32 v[48:49], v[56:57], v[14:15], v[48:49] op_sel_hi:[1,0,1]
    v_pk_fma_f32 v[50:51], v[58:59], v[14:15], v[50:51] op_sel_hi:[1,0,1]
    s_waitcnt vmcnt(0)
    v_xor_b32 v60, s12, v204
    v_xor_b32 v61, s13, v205
    v_xor_b32 v62, s14, v206
    v_xor_b32 v63, s15, v207
    v_or3_b32 v13, v60, v61, v13
    v_or3_b32 v13, v62, v63, v13
    v_cmp_ne_u32_sdwa vcc, v13, 0 src0_sel:BYTE_0 src1_sel:DWORD
    v_pk_fma_f32 v[52:53], v[60:61], v[14:15], v[52:53] op_sel_hi:[1,0,1]
    v_pk_fma_f32 v[54:55], v[62:63], v[14:15], v[54:55] op_sel_hi:[1,0,1]
L_rec_weighed:
    v_permlane32_swap_b32 v48, v50
    v_permlane32_swap_b32 v49, v51
    v_permlane32_swap_b32 v52, v54
    v_permlane32_swap_b32 v53, v55
    v_pk_add_f32 v[48:49], v[48:49], v[50:51]
    v_pk_add_f32 v[52:53], v[52:53], v[54:55]
    s_nop 0
    v_permlane16_swap_b32 v48, v49
    v_permlane16_swap_b32 v52, v53
    v_add_f32 v48, v48, v49
    v_add_f32 v52, v52, v53
    s_cbranch_vccnz L_rec_late
    v_cvt_pk_bf16_f32 v48, v48, v52
    ds_write_b16 v7, v48 offset:0
    ds_write_b16_d16_hi v7, v48 offset:8
    s_waitcnt lgkmcnt(0)
    s_barrier
L_warm_g1:
    s_cbranch_execz L_back_g1
    s_barrier
    s_sleep 2
    buffer_load_dwordx4 v[192:195], v4, s[36:39], s17 offen offset:0 sc1
    buffer_load_dwordx4 v[196:199], v4, s[36:39], s17 offen offset:1024 sc1
    s_sleep 2
L_poll_21:
    buffer_load_dwordx4 v[200:203], v4, s[36:39], s17 offen offset:0 sc1
    buffer_load_dwordx4 v[204:207], v4, s[36:39], s17 offen offset:1024 sc1
    s_waitcnt vmcnt(2)
    v_xor_b32 v48, s12, v192
    v_xor_b32 v49, s13, v193
    v_xor_b32 v50, s14, v194
    v_xor_b32 v51, s15, v195
    v_xor_b32 v52, s12, v196
    v_xor_b32 v53, s13, v197
    v_xor_b32 v54, s14, v198
    v_xor_b32 v55, s15, v199
    v_or_b32 v13, v48, v49
    v_or3_b32 v13, v13, v50, v51
    v_or3_b32 v13, v13, v52, v53
    v_or3_b32 v13, v13, v54, v55
    v_pk_add_f32 v[48:49], v[48:49], v[52:53]
    v_pk_add_f32 v[50:51], v[50:51], v[54:55]
    v_cmpx_ne_u32_sdwa vcc, v13, 0 src0_sel:BYTE_0 src1_sel:DWORD
    s_cbranch_execnz L_more_22
L_polled_23:
    s_mov_b64 exec, -1
    s_nop 1
    v_permlane32_swap_b32 v48, v50
    v_permlane32_swap_b32 v49, v51
    v_pk_add_f32 v[48:49], v[48:49], v[50:51]
    s_nop 1
    v_permlane16_swap_b32 v48, v49
    v_add_f32 v48, v48, v49
    s_nop 1
    v_add_f32_dpp v48, v48, v48 row_ror:8 row_mask:0xf bank_mask:0xf
    s_nop 1
    v_add_f32_dpp v48, v48, v48 row_ror:4 row_mask:0xf bank_mask:0xf
    v_cvt_pk_bf16_f32 v48, v48, v48
    v_lshlrev_b32 v48, 16, v48
    v_add_f32 v48, v48, v11
    s_cmp_eq_u32 s74, 0
    s_nop 0
    v_mov_b32_dpp v49, v48 quad_perm:[1,1,3,3] row_mask:0xf bank_mask:0xf
    v_cvt_pk_bf16_f32 v250, v48, v49
    v_min_u32 v13, -2, v250
    s_mov_b64 exec, s[20:21]
    s_cbranch_scc1 L_h_far
    buffer_store_dword v13, v8, s[40:43], 0 offen
L_h_sent:
    s_mov_b64 exec, -1
    v_lshlrev_b32 v250, 16, v250
    s_sleep 3
    buffer_load_dwordx4 v[192:195], v4, s[36:39], s18 offen sc1
    s_sleep 2
L_poll_24:
    buffer_load_dwordx4 v[196:199], v4, s[36:39], s18 offen sc1
    s_waitcnt vmcnt(1)
    ds_write_b128 v251, v[192:195] offset:2048
    v_pk_mov_b32 v[16:17], v[192:193], v[192:193] op_sel:[0,1]
    v_pk_mov_b32 v[18:19], v[194:195], v[194:195] op_sel:[0,1]
    v_max_u32 v14, v192, v193
    v_max3_u32 v14, v14, v194, v195
    v_cmpx_eq_u32 vcc, -1, v14
    s_cbranch_execnz L_more_25
L_polled_26:
    s_mov_b64 exec, -1
    v_dot2_f32_bf16 v12, v16, s78, 0
    v_dot2_f32_bf16 v13, v16, v16, 0
    v_dot2_f32_bf16 v12, v17, s78, v12
    v_dot2_f32_bf16 v13, v17, v17, v13
    v_dot2_f32_bf16 v12, v18, s78, v12
    v_dot2_f32_bf16 v13, v18, v18, v13
    v_dot2_f32_bf16 v12, v19, s78, v12
    v_dot2_f32_bf16 v13, v19, v19, v13
    s_nop 2
    ds_write_b64 v252, v[12:13] offset:6144
    v_smfmac_f32_16x16x64_bf16 v[32:35], v[16:19], v[64:71], v254
    v_smfmac_f32_16x16x64_bf16 v[40:43], v[16:19], v[128:135], v254
    s_waitcnt lgkmcnt(0)
    s_barrier
    ds_read_b128 v[48:51], v4 offset:6144
    ds_read_b128 v[52:55], v4 offset:7168
    ds_read_b128 v[20:23], v242 offset:2048
    ds_read_b128 v[24:27], v243 offset:2048
    v_smfmac_f32_16x16x64_bf16 v[36:39], v[16:19], v[96:103], v254
    ds_read_b128 v[28:31], v244 offset:2048
    v_smfmac_f32_16x16x64_bf16 v[44:47], v[16:19], v[160:167], v254
    s_waitcnt lgkmcnt(3)
    v_pk_add_f32 v[48:49], v[48:49], v[50:51]
    v_pk_add_f32 v[52:53], v[52:53], v[54:55]
    v_pk_add_f32 v[48:49], v[48:49], v[52:53]
    s_waitcnt lgkmcnt(2)
    v_smfmac_f32_16x16x64_bf16 v[32:35], v[20:23], v[72:79], v254
    v_add_f32_dpp v48, v48, v48 row_ror:8 row_mask:0xf bank_mask:0xf
    v_smfmac_f32_16x16x64_bf16 v[40:43], v[20:23], v[136:143], v254
    v_add_f32_dpp v49, v49, v49 row_ror:8 row_mask:0xf bank_mask:0xf
    v_smfmac_f32_16x16x64_bf16 v[36:39], v[20:23], v[104:111], v254
    v_add_f32_dpp v48, v48, v48 row_ror:4 row_mask:0xf bank_mask:0xf
    v_smfmac_f32_16x16x64_bf16 v[44:47], v[20:23], v[168:175], v254
    v_add_f32_dpp v49, v49, v49 row_ror:4 row_mask:0xf bank_mask:0xf
    s_waitcnt lgkmcnt(1)
    v_smfmac_f32_16x16x64_bf16 v[32:35], v[24:27], v[80:87], v254
    v_add_f32_dpp v48, v48, v48 row_ror:2 row_mask:0xf bank_mask:0xf
    v_smfmac_f32_16x16x64_bf16 v[40:43], v[24:27], v[144:151], v254
    v_add_f32_dpp v49, v49, v49 row_ror:2 row_mask:0xf bank_mask:0xf
    v_smfmac_f32_16x16x64_bf16 v[36:39], v[24:27], v[112:119], v254
    v_add_f32_dpp v48, v48, v48 row_ror:1 row_mask:0xf bank_mask:0xf
    v_smfmac_f32_16x16x64_bf16 v[44:47], v[24:27], v[176:183], v254
    v_add_f32_dpp v49, v49, v49 row_ror:1 row_mask:0xf bank_mask:0xf
    s_waitcnt lgkmcnt(0)
    v_smfmac_f32_16x16x64_bf16 v[32:35], v[28:31], v[88:95], v254
    v_pk_mul_f32 v[12:13], v[48:49], s[22:23]
    v_smfmac_f32_16x16x64_bf16 v[40:43], v[28:31], v[152:159], v254
    v_fma_f32 v13, -v12, v12, v13
    v_max_f32 v13, 0, v13
    v_smfmac_f32_16x16x64_bf16 v[36:39], v[28:31], v[120:127], v254
    v_cvt_pk_bf16_f32 v13, v12, v13
    v_lshlrev_b32 v12, 16, v13
    v_smfmac_f32_16x16x64_bf16 v[44:47], v[28:31], v[184:191], v254
    v_and_b32 v13, 0xffff0000, v13
    v_add_f32 v13, 0x3727c5ac, v13
    v_cvt_pk_bf16_f32 v13, v13, v13
    v_lshlrev_b32 v13, 16, v13
    v_sqrt_f32 v13, v13
    s_nop 0
    v_pk_mul_f32 v[248:249], v[248:249], v[12:13] op_sel_hi:[1,0]
    v_cvt_pk_bf16_f32 v13, v13, v13
    v_lshlrev_b32 v13, 16, v13
    v_rcp_f32 v13, v13
    v_pk_add_f32 v[32:33], v[32:33], v[38:39]
    v_mul_f32 v14, 0xbfb8aa3b, v13
    v_add_f32 v32, v32, v33
    v_sub_f32 v32, v32, v248
    v_mul_f32 v12, v32, v14
    v_exp_f32 v12, v12
    v_pk_add_f32 v[40:41], v[40:41], v[46:47]
    v_add_f32 v12, 1.0, v12
    v_rcp_f32 v12, v12
    v_add_f32 v33, v40, v41
    v_sub_f32 v33, v33, v249
    v_pk_mul_f32 v[32:33], v[32:33], v[12:13] op_sel:[0,1] op_sel_hi:[1,1]
    v_mul_f32 v32, v32, v12
    v_mul_f32 v32, v32, v33
    v_cvt_pk_bf16_f32 v32, v32, v32
    ds_write_b16 v9, v32 offset:512
    s_waitcnt lgkmcnt(0)
    s_barrier
L_warm_g2:
    s_cbranch_execz L_back_g2
    s_barrier
    s_sleep 4
    buffer_load_dwordx4 v[192:195], v4, s[36:39], s17 offen offset:0 sc1
    buffer_load_dwordx4 v[196:199], v4, s[36:39], s17 offen offset:1024 sc1
    s_sleep 1
L_poll_27:
    buffer_load_dwordx4 v[200:203], v4, s[36:39], s17 offen offset:0 sc1
    buffer_load_dwordx4 v[204:207], v4, s[36:39], s17 offen offset:1024 sc1
    s_waitcnt vmcnt(2)
    v_xor_b32 v48, s64, v192
    v_xor_b32 v49, s65, v193
    v_xor_b32 v50, s66, v194
    v_xor_b32 v51, s67, v195
    v_xor_b32 v52, s64, v196
    v_xor_b32 v53, s65, v197
    v_xor_b32 v54, s66, v198
    v_xor_b32 v55, s67, v199
    v_or_b32 v13, v48, v49
    v_or3_b32 v13, v13, v50, v51
    v_or3_b32 v13, v13, v52, v53
    v_or3_b32 v13, v13, v54, v55
    v_pk_add_f32 v[48:49], v[48:49], v[52:53]
    v_pk_add_f32 v[50:51], v[50:51], v[54:55]
    v_cmpx_ne_u32_sdwa vcc, v13, 0 src0_sel:BYTE_0 src1_sel:DWORD
    s_cbranch_execnz L_more_28
L_polled_29:
    s_mov_b64 exec, -1
    s_nop 1
    v_permlane32_swap_b32 v48, v50
    v_permlane32_swap_b32 v49, v51
    v_pk_add_f32 v[48:49], v[48:49], v[50:51]
    s_nop 1
    v_permlane16_swap_b32 v48, v49
    v_add_f32 v48, v48, v49
    s_nop 1
    v_add_f32_dpp v48, v48, v48 row_ror:8 row_mask:0xf bank_mask:0xf
    s_nop 1
    v_add_f32_dpp v48, v48, v48 row_ror:4 row_mask:0xf bank_mask:0xf
    v_cvt_pk_bf16_f32 v48, v48, v48
    v_lshlrev_b32 v48, 16, v48
    v_add_f32 v48, v48, v250
    v_cvt_pk_bf16_f32 v48, v48, v48
    buffer_store_short v48, v10, s[60:63], 0 offen
    s_or_b32 s78, s70, s3
    s_cbranch_scc1 L_fin
    s_add_u32 s78, s85, 0x9e3779b1
    v_mov_b32 v12, s78
    v_mov_b32 v13, 532480
    s_mov_b64 exec, 1
    buffer_store_dword v12, v13, s[40:43], 0 offen
    s_branch L_fin
L_warm_g3:
    s_cbranch_execz L_back_g3
L_h_far:
    buffer_store_dword v13, v8, s[40:43], 0 offen sc1
    s_branch L_h_sent
L_more_16:
    buffer_load_dwordx2 v[224:225], v240, s[36:39], s16 offen sc1
    buffer_load_dwordx2 v[226:227], v241, s[36:39], s16 offen sc1
    s_waitcnt vmcnt(2)
    v_mov_b32 v48, v228
    v_mov_b32 v50, v230
    v_xor_b32 v12, s85, v229
    v_xor_b32 v13, s85, v231
    v_or_b32 v12, v12, v13
    v_cmpx_ne_u32 vcc, 0, v12
    s_cbranch_execz L_polled_17
    s_add_u32 s72, s72, 1
    s_cmp_lt_u32 s72, s71
    s_cbranch_scc1 L_poll_15
    s_branch L_polled_17
L_more_19:
    buffer_load_dwordx4 v[192:195], v5, s[36:39], s84 offen offset:512 sc1
    buffer_load_dwordx4 v[196:199], v5, s[36:39], s84 offen offset:768 sc1
    buffer_load_dwordx4 v[200:203], v6, s[36:39], s84 offen offset:512 sc1
    buffer_load_dwordx4 v[204:207], v6, s[36:39], s84 offen offset:768 sc1
    s_waitcnt vmcnt(4)
    v_xor_b32 v48, s12, v208
    v_xor_b32 v49, s13, v209
    v_xor_b32 v50, s14, v210
    v_xor_b32 v51, s15, v211
    v_xor_b32 v52, s12, v212
    v_xor_b32 v53, s13, v213
    v_xor_b32 v54, s14, v214
    v_xor_b32 v55, s15, v215
    v_xor_b32 v56, s12, v216
    v_xor_b32 v57, s13, v217
    v_xor_b32 v58, s14, v218
    v_xor_b32 v59, s15, v219
    v_xor_b32 v60, s12, v220
    v_xor_b32 v61, s13, v221
    v_xor_b32 v62, s14, v222
    v_xor_b32 v63, s15, v223
    v_or_b32 v13, v48, v49
    v_or3_b32 v13, v13, v50, v51
    v_or3_b32 v13, v13, v52, v53
    v_or3_b32 v13, v13, v54, v55
    v_or3_b32 v13, v13, v56, v57
    v_or3_b32 v13, v13, v58, v59
    v_or3_b32 v13, v13, v60, v61
    v_or3_b32 v13, v13, v62, v63
    v_cmpx_ne_u32_sdwa vcc, v13, 0 src0_sel:BYTE_0 src1_sel:DWORD
    s_cbranch_execz L_polled_20
    s_add_u32 s72, s72, 1
    s_cmp_lt_u32 s72, s71
    s_cbranch_scc1 L_poll_18
    s_branch L_polled_20
L_rec_late:
    buffer_load_dwordx4 v[192:195], v5, s[36:39], s84 offen offset:512 sc1
    buffer_load_dwordx4 v[196:199], v5, s[36:39], s84 offen offset:768 sc1
    buffer_load_dwordx4 v[200:203], v6, s[36:39], s84 offen offset:512 sc1
    buffer_load_dwordx4 v[204:207], v6, s[36:39], s84 offen offset:768 sc1
    s_sleep 2
L_poll_18:
    buffer_load_dwordx4 v[208:211], v5, s[36:39], s84 offen offset:512 sc1
    buffer_load_dwordx4 v[212:215], v5, s[36:39], s84 offen offset:768 sc1
    buffer_load_dwordx4 v[216:219], v6, s[36:39], s84 offen offset:512 sc1
    buffer_load_dwordx4 v[220:223], v6, s[36:39], s84 offen offset:768 sc1
    s_waitcnt vmcnt(4)
    v_xor_b32 v48, s12, v192
    v_xor_b32 v49, s13, v193
    v_xor_b32 v50, s14, v194
    v_xor_b32 v51, s15, v195
    v_xor_b32 v52, s12, v196
    v_xor_b32 v53, s13, v197
    v_xor_b32 v54, s14, v198
    v_xor_b32 v55, s15, v199
    v_xor_b32 v56, s12, v200
    v_xor_b32 v57, s13, v201
    v_xor_b32 v58, s14, v202
    v_xor_b32 v59, s15, v203
    v_xor_b32 v60, s12, v204
    v_xor_b32 v61, s13, v205
    v_xor_b32 v62, s14, v206
    v_xor_b32 v63, s15, v207
    v_or_b32 v13, v48, v49
    v_or3_b32 v13, v13, v50, v51
    v_or3_b32 v13, v13, v52, v53
    v_or3_b32 v13, v13, v54, v55
    v_or3_b32 v13, v13, v56, v57
    v_or3_b32 v13, v13, v58, v59
    v_or3_b32 v13, v13, v60, v61
    v_or3_b32 v13, v13, v62, v63
    v_cmpx_ne_u32_sdwa vcc, v13, 0 src0_sel:BYTE_0 src1_sel:DWORD
    s_cbranch_execnz L_more_19
L_polled_20:
    s_mov_b64 exec, -1
    v_pk_mul_f32 v[48:49], v[48:49], v[12:13] op_sel_hi:[1,0]
    v_pk_mul_f32 v[50:51], v[50:51], v[12:13] op_sel_hi:[1,0]
    v_pk_mul_f32 v[52:53], v[52:53], v[12:13] op_sel_hi:[1,0]
    v_pk_mul_f32 v[54:55], v[54:55], v[12:13] op_sel_hi:[1,0]
    v_pk_fma_f32 v[48:49], v[56:57], v[14:15], v[48:49] op_sel_hi:[1,0,1]
    v_pk_fma_f32 v[50:51], v[58:59], v[14:15], v[50:51] op_sel_hi:[1,0,1]
    v_pk_fma_f32 v[52:53], v[60:61], v[14:15], v[52:53] op_sel_hi:[1,0,1]
    v_pk_fma_f32 v[54:55], v[62:63], v[14:15], v[54:55] op_sel_hi:[1,0,1]
    s_mov_b64 vcc, 0
    s_branch L_rec_weighed
L_more_22:
    buffer_load_dwordx4 v[192:195], v4, s[36:39], s17 offen offset:0 sc1
    buffer_load_dwordx4 v[196:199], v4, s[36:39], s17 offen offset:1024 sc1
    s_waitcnt vmcnt(2)
    v_xor_b32 v48, s12, v200
    v_xor_b32 v49, s13, v201
    v_xor_b32 v50, s14, v202
    v_xor_b32 v51, s15, v203
    v_xor_b32 v52, s12, v204
    v_xor_b32 v53, s13, v205
    v_xor_b32 v54, s14, v206
    v_xor_b32 v55, s15, v207
    v_or_b32 v13, v48, v49
    v_or3_b32 v13, v13, v50, v51
    v_or3_b32 v13, v13, v52, v53
    v_or3_b32 v13, v13, v54, v55
    v_pk_add_f32 v[48:49], v[48:49], v[52:53]
    v_pk_add_f32 v[50:51], v[50:51], v[54:55]
    v_cmpx_ne_u32_sdwa vcc, v13, 0 src0_sel:BYTE_0 src1_sel:DWORD
    s_cbranch_execz L_polled_23
    s_add_u32 s72, s72, 1
    s_cmp_lt_u32 s72, s71
    s_cbranch_scc1 L_poll_21
    s_branch L_polled_23
L_more_25:
    buffer_load_dwordx4 v[192:195], v4, s[36:39], s18 offen sc1
    s_waitcnt vmcnt(1)
    ds_write_b128 v251, v[196:199] offset:2048
    v_pk_mov_b32 v[16:17], v[196:197], v[196:197] op_sel:[0,1]
    v_pk_mov_b32 v[18:19], v[198:199], v[198:199] op_sel:[0,1]
    v_max_u32 v14, v196, v197
    v_max3_u32 v14, v14, v198, v199
    v_cmpx_eq_u32 vcc, -1, v14
    s_cbranch_execz L_polled_26
    s_add_u32 s72, s72, 1
    s_cmp_lt_u32 s72, s71
    s_cbranch_scc1 L_poll_24
    s_branch L_polled_26
L_more_28:
    buffer_load_dwordx4 v[192:195], v4, s[36:39], s17 offen offset:0 sc1
    buffer_load_dwordx4 v[196:199], v4, s[36:39], s17 offen offset:1024 sc1
    s_waitcnt vmcnt(2)
    v_xor_b32 v48, s64, v200
    v_xor_b32 v49, s65, v201
    v_xor_b32 v50, s66, v202
    v_xor_b32 v51, s67, v203
    v_xor_b32 v52, s64, v204
    v_xor_b32 v53, s65, v205
    v_xor_b32 v54, s66, v206
    v_xor_b32 v55, s67, v207
    v_or_b32 v13, v48, v49
    v_or3_b32 v13, v13, v50, v51
    v_or3_b32 v13, v13, v52, v53
    v_or3_b32 v13, v13, v54, v55
    v_pk_add_f32 v[48:49], v[48:49], v[52:53]
    v_pk_add_f32 v[50:51], v[50:51], v[54:55]
    v_cmpx_ne_u32_sdwa vcc, v13, 0 src0_sel:BYTE_0 src1_sel:DWORD
    s_cbranch_execz L_polled_29
    s_add_u32 s72, s72, 1
    s_cmp_lt_u32 s72, s71
    s_cbranch_scc1 L_poll_27
    s_branch L_polled_29
L_fin:
L_end:
    s_endpgm
L_code_end:
.section .rodata,"a"
.p2align 6
.amdhsa_kernel sequential_preLN__sliding_block_cached__swiglu_ffn__decode_kernel
  .amdhsa_next_free_vgpr 256
  .amdhsa_next_free_sgpr 102
  .amdhsa_accum_offset 256
  .amdhsa_group_segment_fixed_size 0
  .amdhsa_kernarg_size 96
  .amdhsa_user_sgpr_count 2
  .amdhsa_user_sgpr_kernarg_segment_ptr 1
  .amdhsa_system_sgpr_workgroup_id_x 1
  .amdhsa_float_denorm_mode_32 3
.end_amdhsa_kernel
```
